```python
import torch

def _softmax(x, axis=-1):
    return torch.softmax(x, dim=axis)

def _gelu(x):
    return torch.nn.functional.gelu(x, approximate='tanh')

def _silu(x):
    return torch.nn.functional.silu(x)

def _sigmoid(x):
    return torch.sigmoid(x)

def _layernorm(x, axis=-1, eps=1e-05):
    m = x.mean(dim=axis, keepdim=True)
    v = x.var(dim=axis, keepdim=True, unbiased=False)
    return (x - m) / torch.sqrt(v + eps)

def _scatter_add(tgt, idx, src, axis=0):
    return tgt.clone().index_add_(axis, idx, src)

def _segment_sum(src, seg, n):
    out = torch.zeros((n,) + src.shape[1:], dtype=src.dtype)
    return out.index_add_(0, seg, src)

def _pad(x, pw):
    flat = tuple((v for pair in reversed(pw) for v in pair))
    return torch.nn.functional.pad(x, flat)
kernel_name = 'adaLN_cond__gqa_block_cached__geglu_ffn__decode'

def setup_inputs():

    _w = lambda a: (lambda t: t.to(torch.bfloat16) if t.is_floating_point() else t)(torch.as_tensor(a))

    def _A_setup():
        B, Sq, D = (4, 1, 640)
        Hq, Hkv, Sk, Dh = (32, 32, 4096, 192)
        assert Hq % Hkv == 0, (Hq, Hkv)
        return {'x': _w((lambda *s: torch.randn(*s, dtype=torch.bfloat16) * 0.05)(B, Sq, D)), 'k_cache': _w((lambda *s: torch.randn(*s, dtype=torch.bfloat16) * 3.2)(B, Hkv, Sk, Dh)), 'v_cache': _w((lambda *s: torch.randn(*s, dtype=torch.bfloat16) * 0.4)(B, Hkv, Sk, Dh)), 'wq': _w((lambda *s: torch.randn(*s, dtype=torch.bfloat16) * 3.2)(D, Hq * Dh) * D ** (-0.5)), 'wo': _w((lambda *s: torch.randn(*s, dtype=torch.bfloat16) * 0.4)(Hq * Dh, D) * (Hq * Dh) ** (-0.5))}
    _A_in = _A_setup()

    def _B_setup():
        B, S, D, F = (4, 1, 640, 1536)
        return {'x': _w((lambda *s: torch.randn(*s, dtype=torch.bfloat16) * 0.05)(B, S, D)), 'w_gate': _w((lambda *s: torch.randn(*s, dtype=torch.bfloat16) * 0.05)(D, F)), 'w_up': _w((lambda *s: torch.randn(*s, dtype=torch.bfloat16) * 0.05)(D, F)), 'w_down': _w((lambda *s: torch.randn(*s, dtype=torch.bfloat16) * 0.05)(F, D))}
    _B_in = _B_setup()
    return {'A_x': _A_in['x'], 'A_k_cache': _A_in['k_cache'], 'A_v_cache': _A_in['v_cache'], 'A_wq': _A_in['wq'], 'A_wo': _A_in['wo'], 'B_x': _B_in['x'], 'B_w_gate': _B_in['w_gate'], 'B_w_up': _B_in['w_up'], 'B_w_down': _B_in['w_down'], 'c': _w((lambda *s: torch.randn(*s, dtype=torch.bfloat16) * 0.1)(4, 640) * 8.0), 'w_mod': _w((lambda *s: torch.randn(*s, dtype=torch.bfloat16) * 0.1)(640, 6 * 640) * 640 ** (-0.5) * 8.0)}

def reference(A_x, A_k_cache, A_v_cache, A_wq, A_wo, B_x, B_w_gate, B_w_up, B_w_down, c, w_mod):

    def _A_ref(x, k_cache, v_cache, wq, wo):
        B, Sq, D = x.shape
        Hq, Dh = (32, 192)
        Hkv = k_cache.shape[1]
        rep = Hq // Hkv
        q = (lambda x, *d: x.permute(*d))((x @ wq).reshape(B, Sq, Hq, Dh), 0, 2, 1, 3)
        k = (lambda x, n, axis: torch.repeat_interleave(x, n, dim=axis))(k_cache, rep, axis=1)
        v = (lambda x, n, axis: torch.repeat_interleave(x, n, dim=axis))(v_cache, rep, axis=1)
        scores = torch.einsum('bhqd,bhkd->bhqk', q, k) * Dh ** (-0.5)
        p = _softmax(scores, axis=-1)
        o = torch.einsum('bhqk,bhkd->bhqd', p, v)
        return (lambda x, *d: x.permute(*d))(o, 0, 2, 1, 3).reshape(B, Sq, Hq * Dh) @ wo

    def _B_ref(x, w_gate, w_up, w_down):
        return _gelu(x @ w_gate) * (x @ w_up) @ w_down
    x = A_x
    mod = (_silu(c) @ w_mod).reshape(c.shape[0], 6, 1, -1)
    sa, ca, ga, sb, cb, gb = (mod[:, 0].clone(), mod[:, 1].clone(), mod[:, 2].clone(), mod[:, 3].clone(), mod[:, 4].clone(), mod[:, 5].clone())
    h = _layernorm(x, axis=-1) * (1 + ca) + sa
    x = x + ga * _A_ref(h, A_k_cache, A_v_cache, A_wq, A_wo)
    h = _layernorm(x, axis=-1) * (1 + cb) + sb
    x = x + gb * _B_ref(h, B_w_gate, B_w_up, B_w_down)
    return x
```

```asm
; @launch grid=(256,1,1) block=(832,1,1) lds=141312
.amdgcn_target "amdgcn-amd-amdhsa--gfx950"
.text
.globl adaLN_cond__gqa_block_cached__geglu_ffn__decode_kernel
.p2align 8
.type adaLN_cond__gqa_block_cached__geglu_ffn__decode_kernel,@function
adaLN_cond__gqa_block_cached__geglu_ffn__decode_kernel:
    s_cmp_ge_u32 s2, 256
    s_cbranch_scc1 L_end
    s_load_dwordx16 s[16:31], s[0:1], 0
    s_load_dwordx8 s[32:39], s[0:1], 64
    s_load_dwordx2 s[40:41], s[0:1], 104
    v_lshrrev_b32 v1, 6, v0
    v_and_b32 v0, 63, v0
    v_readfirstlane_b32 s4, v1
    s_and_b32 s5, s2, 7
    s_lshr_b32 s6, s2, 3
    s_lshr_b32 s3, s6, 3
    s_lshl_b32 s7, s5, 2
    s_add_u32 s7, s7, s3
    s_and_b32 s8, s6, 7
    s_mov_b32 s95, 0x80000
    s_lshr_b32 s3, s6, 1
    s_and_b32 s13, s6, 1
    s_mov_b32 s60, 0
    s_sub_u32 s61, s6, 20
    s_mov_b32 s63, 0
    s_cmp_ge_u32 s3, 11
    s_cbranch_scc1 L_roled
    s_lshl_b32 s14, s3, 3
    s_add_u32 s14, s14, s5
    s_cmp_lt_u32 s3, 5
    s_cselect_b32 s63, 4, 5
    s_cmp_ge_u32 s14, 60
    s_cselect_b32 s63, 8, s63
    s_cmp_ge_u32 s3, 9
    s_cselect_b32 s63, 3, s63
    s_cmp_eq_u32 s13, 0
    s_cbranch_scc1 L_role0
    s_sub_u32 s61, s3, 9
    s_cmp_ge_u32 s3, 9
    s_cbranch_scc1 L_roled
    s_mov_b32 s61, s14
    s_cmp_lt_u32 s14, 60
    s_cselect_b32 s60, 1, 4
    s_branch L_roled
L_role0:
    s_cmp_lt_u32 s3, 5
    s_cselect_b32 s60, 3, 2
    s_cselect_b32 s14, 5, 6
    s_cselect_b32 s15, 0, 5
    s_mul_i32 s61, s5, s14
    s_add_u32 s61, s61, s3
    s_sub_u32 s61, s61, s15
L_roled:
    s_cmp_lt_u32 s4, 5
    s_cbranch_scc1 L_service
    v_mul_u32_u24 v1, 12, v0
    v_add_u32 v2, 3840, v1
    s_lshr_b32 s3, s8, 1
    s_lshl_b32 s3, s3, 5
    s_add_u32 s3, s3, s7
    s_mul_i32 s12, s3, 1572864
    s_mul_i32 s42, s3, 3
    s_mul_hi_u32 s86, s42, 306783379
    s_mul_i32 s86, s86, 14
    s_sub_u32 s42, s42, s86
    s_lshl_b32 s42, s42, 4
    s_lshl_b32 s86, s13, 3
    s_mul_i32 s87, s13, 255
    s_add_u32 s87, s87, 112
    s_cmp_eq_u32 s13, 0
    s_cselect_b32 s94, 1, -1
    s_mul_i32 s63, s63, s94
    s_sub_u32 s63, 128, s63
    s_sub_u32 s11, s4, 5
    s_and_b32 s10, s11, -8
    s_add_u32 s10, s10, s11
    s_add_u32 s10, s10, s86
    s_add_u32 s10, s10, s42
    s_sub_u32 s3, s10, 224
    s_cmp_ge_u32 s10, 224
    s_cselect_b32 s10, s3, s10
    s_mul_i32 s3, s11, s94
    s_add_u32 s3, s3, s87
    s_cmp_lt_u32 s11, 112
    s_cselect_b32 s10, s10, s3
    s_mul_i32 s10, s10, 6144
    s_cmp_lt_u32 s61, 20
    s_cselect_b32 s15, 2, 0
    s_cmp_eq_u32 s60, 1
    s_cselect_b32 s15, s15, 0
    s_cmp_eq_u32 s60, 0
    s_cselect_b32 s15, 1, s15
    v_mov_b32 v29, 0
    v_mov_b32 v30, 1
    s_waitcnt lgkmcnt(0)
    s_add_u32 s48, s18, s12
    s_addc_u32 s49, s19, 0
    s_mov_b32 s50, 1572864
    s_mov_b32 s51, 0x20000
    s_add_u32 s52, s20, s12
    s_addc_u32 s53, s21, 0
    s_mov_b32 s54, 1572864
    s_mov_b32 s55, 0x20000
    s_load_dword s9, s[40:41], 0
    s_cmp_eq_u32 s15, 0
    s_cbranch_scc1 L_hold2_x
    s_barrier
    s_cmp_eq_u32 s15, 2
    s_cbranch_scc0 L_hold2_x
L_hold2:
    ds_read_b32 v16, v29 offset:4
    s_waitcnt lgkmcnt(0)
    v_readfirstlane_b32 s14, v16
    s_cmp_ge_u32 s14, 4
    s_cbranch_scc1 L_hold2_x
    s_sleep 2
    s_sub_u32 s95, s95, 1
    s_cbranch_scc0 L_hold2
    s_mov_b32 s95, 0
L_hold2_x:
    buffer_load_dwordx3 v[32:34], v1, s[48:51], s10 offen offset:0 nt
    buffer_load_dwordx3 v[36:38], v1, s[48:51], s10 offen offset:768 nt
    buffer_load_dwordx3 v[40:42], v1, s[48:51], s10 offen offset:1536 nt
    s_cmp_eq_u32 s15, 1
    s_cbranch_scc0 L_qp3
    s_waitcnt vmcnt(2)
    ds_read_b32 v16, v29 offset:4
    s_waitcnt lgkmcnt(0)
    v_readfirstlane_b32 s14, v16
    s_cmp_ge_u32 s14, 4
    s_cselect_b32 s15, 3, 1
L_qp3:
    buffer_load_dwordx3 v[44:46], v1, s[48:51], s10 offen offset:2304 nt
    s_cmp_eq_u32 s15, 1
    s_cbranch_scc0 L_qp4
    s_waitcnt vmcnt(2)
    ds_read_b32 v16, v29 offset:4
    s_waitcnt lgkmcnt(0)
    v_readfirstlane_b32 s14, v16
    s_cmp_ge_u32 s14, 4
    s_cselect_b32 s15, 3, 1
L_qp4:
    buffer_load_dwordx3 v[48:50], v1, s[48:51], s10 offen offset:3072 nt
    s_cmp_eq_u32 s15, 1
    s_cbranch_scc0 L_qp5
    s_waitcnt vmcnt(2)
    ds_read_b32 v16, v29 offset:4
    s_waitcnt lgkmcnt(0)
    v_readfirstlane_b32 s14, v16
    s_cmp_ge_u32 s14, 4
    s_cselect_b32 s15, 3, 1
L_qp5:
    buffer_load_dwordx3 v[52:54], v2, s[48:51], s10 offen offset:0 nt
    s_cmp_eq_u32 s15, 1
    s_cbranch_scc0 L_qp6
    s_waitcnt vmcnt(2)
    ds_read_b32 v16, v29 offset:4
    s_waitcnt lgkmcnt(0)
    v_readfirstlane_b32 s14, v16
    s_cmp_ge_u32 s14, 4
    s_cselect_b32 s15, 3, 1
L_qp6:
    buffer_load_dwordx3 v[56:58], v2, s[48:51], s10 offen offset:768 nt
    s_cmp_eq_u32 s15, 1
    s_cbranch_scc0 L_qp7
    s_waitcnt vmcnt(2)
    ds_read_b32 v16, v29 offset:4
    s_waitcnt lgkmcnt(0)
    v_readfirstlane_b32 s14, v16
    s_cmp_ge_u32 s14, 4
    s_cselect_b32 s15, 3, 1
L_qp7:
    buffer_load_dwordx3 v[60:62], v2, s[48:51], s10 offen offset:1536 nt
    s_cmp_eq_u32 s15, 1
    s_cbranch_scc0 L_qp8
    s_waitcnt vmcnt(2)
    ds_read_b32 v16, v29 offset:4
    s_waitcnt lgkmcnt(0)
    v_readfirstlane_b32 s14, v16
    s_cmp_ge_u32 s14, 4
    s_cselect_b32 s15, 3, 1
L_qp8:
    s_add_u32 s13, s11, 8
    s_and_b32 s10, s13, -8
    s_add_u32 s10, s10, s13
    s_add_u32 s10, s10, s86
    s_add_u32 s10, s10, s42
    s_sub_u32 s3, s10, 224
    s_cmp_ge_u32 s10, 224
    s_cselect_b32 s10, s3, s10
    s_mul_i32 s3, s13, s94
    s_add_u32 s3, s3, s87
    s_cmp_lt_u32 s13, 112
    s_cselect_b32 s10, s10, s3
    s_mul_i32 s10, s10, 6144
    buffer_load_dwordx3 v[64:66], v1, s[48:51], s10 offen offset:0 nt
    s_cmp_eq_u32 s15, 1
    s_cbranch_scc0 L_qp9
    s_waitcnt vmcnt(2)
    ds_read_b32 v16, v29 offset:4
    s_waitcnt lgkmcnt(0)
    v_readfirstlane_b32 s14, v16
    s_cmp_ge_u32 s14, 4
    s_cselect_b32 s15, 3, 1
L_qp9:
    buffer_load_dwordx3 v[68:70], v1, s[48:51], s10 offen offset:768 nt
    s_cmp_eq_u32 s15, 1
    s_cbranch_scc0 L_qp10
    s_waitcnt vmcnt(2)
    ds_read_b32 v16, v29 offset:4
    s_waitcnt lgkmcnt(0)
    v_readfirstlane_b32 s14, v16
    s_cmp_ge_u32 s14, 4
    s_cselect_b32 s15, 3, 1
L_qp10:
    buffer_load_dwordx3 v[72:74], v1, s[48:51], s10 offen offset:1536 nt
    s_cmp_eq_u32 s15, 1
    s_cbranch_scc0 L_qp11
    s_waitcnt vmcnt(2)
    ds_read_b32 v16, v29 offset:4
    s_waitcnt lgkmcnt(0)
    v_readfirstlane_b32 s14, v16
    s_cmp_ge_u32 s14, 4
    s_cselect_b32 s15, 3, 1
L_qp11:
    buffer_load_dwordx3 v[76:78], v1, s[48:51], s10 offen offset:2304 nt
    s_cmp_eq_u32 s15, 1
    s_cbranch_scc0 L_qp12
    s_waitcnt vmcnt(2)
    ds_read_b32 v16, v29 offset:4
    s_waitcnt lgkmcnt(0)
    v_readfirstlane_b32 s14, v16
    s_cmp_ge_u32 s14, 4
    s_cselect_b32 s15, 3, 1
L_qp12:
    buffer_load_dwordx3 v[80:82], v1, s[48:51], s10 offen offset:3072 nt
    s_cmp_eq_u32 s15, 1
    s_cbranch_scc0 L_qp13
    s_waitcnt vmcnt(2)
    ds_read_b32 v16, v29 offset:4
    s_waitcnt lgkmcnt(0)
    v_readfirstlane_b32 s14, v16
    s_cmp_ge_u32 s14, 4
    s_cselect_b32 s15, 3, 1
L_qp13:
    buffer_load_dwordx3 v[84:86], v2, s[48:51], s10 offen offset:0 nt
    s_cmp_eq_u32 s15, 1
    s_cbranch_scc0 L_qp14
    s_waitcnt vmcnt(2)
    ds_read_b32 v16, v29 offset:4
    s_waitcnt lgkmcnt(0)
    v_readfirstlane_b32 s14, v16
    s_cmp_ge_u32 s14, 4
    s_cselect_b32 s15, 3, 1
L_qp14:
    buffer_load_dwordx3 v[88:90], v2, s[48:51], s10 offen offset:768 nt
    s_cmp_eq_u32 s15, 1
    s_cbranch_scc0 L_qp15
    s_waitcnt vmcnt(2)
    ds_read_b32 v16, v29 offset:4
    s_waitcnt lgkmcnt(0)
    v_readfirstlane_b32 s14, v16
    s_cmp_ge_u32 s14, 4
    s_cselect_b32 s15, 3, 1
L_qp15:
    buffer_load_dwordx3 v[92:94], v2, s[48:51], s10 offen offset:1536 nt
    s_cmp_eq_u32 s15, 1
    s_cbranch_scc0 L_qp16
    s_waitcnt vmcnt(2)
    ds_read_b32 v16, v29 offset:4
    s_waitcnt lgkmcnt(0)
    v_readfirstlane_b32 s14, v16
    s_cmp_ge_u32 s14, 4
    s_cselect_b32 s15, 3, 1
L_qp16:
    s_add_u32 s13, s11, 16
    s_and_b32 s10, s13, -8
    s_add_u32 s10, s10, s13
    s_add_u32 s10, s10, s86
    s_add_u32 s10, s10, s42
    s_sub_u32 s3, s10, 224
    s_cmp_ge_u32 s10, 224
    s_cselect_b32 s10, s3, s10
    s_mul_i32 s3, s13, s94
    s_add_u32 s3, s3, s87
    s_cmp_lt_u32 s13, 112
    s_cselect_b32 s10, s10, s3
    s_mul_i32 s10, s10, 6144
    buffer_load_dwordx3 v[96:98], v1, s[48:51], s10 offen offset:0 nt
    s_cmp_eq_u32 s15, 1
    s_cbranch_scc0 L_qp17
    s_waitcnt vmcnt(2)
    ds_read_b32 v16, v29 offset:4
    s_waitcnt lgkmcnt(0)
    v_readfirstlane_b32 s14, v16
    s_cmp_ge_u32 s14, 4
    s_cselect_b32 s15, 3, 1
L_qp17:
    buffer_load_dwordx3 v[100:102], v1, s[48:51], s10 offen offset:768 nt
    s_cmp_eq_u32 s15, 1
    s_cbranch_scc0 L_qp18
    s_waitcnt vmcnt(2)
    ds_read_b32 v16, v29 offset:4
    s_waitcnt lgkmcnt(0)
    v_readfirstlane_b32 s14, v16
    s_cmp_ge_u32 s14, 4
    s_cselect_b32 s15, 3, 1
L_qp18:
    buffer_load_dwordx3 v[104:106], v1, s[48:51], s10 offen offset:1536 nt
    s_cmp_eq_u32 s15, 1
    s_cbranch_scc0 L_qp19
    s_waitcnt vmcnt(2)
    ds_read_b32 v16, v29 offset:4
    s_waitcnt lgkmcnt(0)
    v_readfirstlane_b32 s14, v16
    s_cmp_ge_u32 s14, 4
    s_cselect_b32 s15, 3, 1
L_qp19:
    buffer_load_dwordx3 v[108:110], v1, s[48:51], s10 offen offset:2304 nt
    s_cmp_eq_u32 s15, 1
    s_cbranch_scc0 L_qp20
    s_waitcnt vmcnt(2)
    ds_read_b32 v16, v29 offset:4
    s_waitcnt lgkmcnt(0)
    v_readfirstlane_b32 s14, v16
    s_cmp_ge_u32 s14, 4
    s_cselect_b32 s15, 3, 1
L_qp20:
    buffer_load_dwordx3 v[112:114], v1, s[48:51], s10 offen offset:3072 nt
    s_cmp_eq_u32 s15, 1
    s_cbranch_scc0 L_qp21
    s_waitcnt vmcnt(2)
    ds_read_b32 v16, v29 offset:4
    s_waitcnt lgkmcnt(0)
    v_readfirstlane_b32 s14, v16
    s_cmp_ge_u32 s14, 4
    s_cselect_b32 s15, 3, 1
L_qp21:
    buffer_load_dwordx3 v[116:118], v2, s[48:51], s10 offen offset:0 nt
    s_cmp_eq_u32 s15, 1
    s_cbranch_scc0 L_qp22
    s_waitcnt vmcnt(2)
    ds_read_b32 v16, v29 offset:4
    s_waitcnt lgkmcnt(0)
    v_readfirstlane_b32 s14, v16
    s_cmp_ge_u32 s14, 4
    s_cselect_b32 s15, 3, 1
L_qp22:
    buffer_load_dwordx3 v[120:122], v2, s[48:51], s10 offen offset:768 nt
    s_cmp_eq_u32 s15, 1
    s_cbranch_scc0 L_qp23
    s_waitcnt vmcnt(2)
    ds_read_b32 v16, v29 offset:4
    s_waitcnt lgkmcnt(0)
    v_readfirstlane_b32 s14, v16
    s_cmp_ge_u32 s14, 4
    s_cselect_b32 s15, 3, 1
L_qp23:
    buffer_load_dwordx3 v[124:126], v2, s[48:51], s10 offen offset:1536 nt
    s_cmp_eq_u32 s15, 0
    s_cbranch_scc0 L_nobar
    s_barrier
L_nobar:
    s_mul_i32 s14, s7, 3072
    s_lshr_b32 s3, s8, 1
    s_lshl_b32 s3, s3, 6
    s_add_u32 s14, s14, s3
    s_add_u32 s14, s14, 106496
    s_lshl_b32 s3, s11, 9
    s_add_u32 s14, s14, s3
    s_add_u32 s84, s40, s14
    s_addc_u32 s85, s41, 0
    v_and_b32 v3, 31, v0
    v_mul_u32_u24 v3, 12, v3
    s_lshl_b32 s3, s11, 6
    v_lshlrev_b32 v31, 2, v0
    v_add_u32 v31, s3, v31
    s_lshl_b32 s3, s11, 10
    s_add_u32 s3, s3, 10880
    v_lshlrev_b32 v7, 4, v0
    v_add_u32 v7, s3, v7
    s_mov_b32 s56, 0xcccccccc
    s_mov_b32 s57, 0xcccccccc
    s_mov_b32 s58, 0x3fb8aa3b
    s_mov_b32 s59, 0x3d93cd3a
    s_mov_b32 s43, 1572864
    v_mov_b32 v8, 0
    v_mov_b32 v9, 0
    v_mov_b32 v10, 0
    v_mov_b32 v11, 0
    v_mov_b32 v12, 0
    v_mov_b32 v13, 0
    v_mov_b32 v14, 0xff7fffff
    v_mov_b32 v15, 0
    s_waitcnt lgkmcnt(0)
    s_mul_i32 s9, s9, 0x9e3779b1
    s_add_u32 s9, s9, 0x7f4a7c15
    s_cmp_lt_u32 s11, 6
    s_cbranch_scc0 L_qw
    s_branch L_qpoll
L_qretry:
    s_sleep 4
    s_sub_u32 s95, s95, 1
    s_cbranch_scc0 L_qpoll
    s_mov_b32 s95, 0
    s_branch L_qgot
L_qpoll:
    s_load_dwordx16 s[16:31], s[84:85], 0 glc
    s_load_dwordx8 s[32:39], s[84:85], 256 glc
    s_load_dwordx8 s[76:83], s[84:85], 288 glc
    s_waitcnt lgkmcnt(0)
    s_cmp_eq_u32 s17, s9
    s_cbranch_scc0 L_qretry
    s_cmp_eq_u32 s19, s9
    s_cbranch_scc0 L_qretry
    s_cmp_eq_u32 s21, s9
    s_cbranch_scc0 L_qretry
    s_cmp_eq_u32 s23, s9
    s_cbranch_scc0 L_qretry
    s_cmp_eq_u32 s25, s9
    s_cbranch_scc0 L_qretry
    s_cmp_eq_u32 s27, s9
    s_cbranch_scc0 L_qretry
    s_cmp_eq_u32 s29, s9
    s_cbranch_scc0 L_qretry
    s_cmp_eq_u32 s31, s9
    s_cbranch_scc0 L_qretry
    s_cmp_eq_u32 s33, s9
    s_cbranch_scc0 L_qretry
    s_cmp_eq_u32 s35, s9
    s_cbranch_scc0 L_qretry
    s_cmp_eq_u32 s37, s9
    s_cbranch_scc0 L_qretry
    s_cmp_eq_u32 s39, s9
    s_cbranch_scc0 L_qretry
    s_cmp_eq_u32 s77, s9
    s_cbranch_scc0 L_qretry
    s_cmp_eq_u32 s79, s9
    s_cbranch_scc0 L_qretry
    s_cmp_eq_u32 s81, s9
    s_cbranch_scc0 L_qretry
    s_cmp_eq_u32 s83, s9
    s_cbranch_scc0 L_qretry
L_qgot:
    v_writelane_b32 v16, s16, 0
    v_writelane_b32 v16, s18, 1
    v_writelane_b32 v16, s20, 2
    v_writelane_b32 v16, s22, 3
    v_writelane_b32 v16, s24, 4
    v_writelane_b32 v16, s26, 5
    v_writelane_b32 v16, s28, 6
    v_writelane_b32 v16, s30, 7
    v_writelane_b32 v16, s32, 8
    v_writelane_b32 v16, s34, 9
    v_writelane_b32 v16, s36, 10
    v_writelane_b32 v16, s38, 11
    v_writelane_b32 v16, s76, 12
    v_writelane_b32 v16, s78, 13
    v_writelane_b32 v16, s80, 14
    v_writelane_b32 v16, s82, 15
    s_mov_b64 exec, 0xffff
    ds_write_b32 v31, v16 offset:49792
    s_mov_b64 exec, 1
    ds_add_u32 v29, v30 offset:12
    s_mov_b64 exec, -1
L_qw:
    ds_read_b32 v16, v29 offset:12
    s_waitcnt lgkmcnt(0)
    v_readfirstlane_b32 s14, v16
    s_cmp_ge_u32 s14, 6
    s_cbranch_scc1 L_qw_x
    s_sleep 1
    s_sub_u32 s95, s95, 1
    s_cbranch_scc0 L_qw
    s_mov_b32 s95, 0
L_qw_x:
    ds_read_b32 v4, v3 offset:49792
    ds_read_b32 v5, v3 offset:49796
    ds_read_b32 v6, v3 offset:49800
    s_waitcnt lgkmcnt(0)
    s_mov_b32 s12, s11
    s_sub_u32 s15, s63, s11
    s_add_u32 s15, s15, 7
    s_lshr_b32 s15, s15, 3
    s_mov_b32 s13, s15
    s_add_u32 s11, s11, 16
    v_lshrrev_b32 v28, 5, v0
    v_lshlrev_b32 v28, 3, v28
    v_bfe_u32 v29, v0, 1, 3
    v_add_u32 v28, v28, v29
    v_lshlrev_b32 v28, 2, v28
    s_mul_i32 s3, s12, 1152
    s_add_u32 s3, s3, 132096
    v_add_u32 v28, s3, v28
    v_mov_b32 v29, v28
L_k0:
    s_add_u32 s11, s11, 8
    s_cmp_ge_u32 s11, s63
    s_cbranch_scc0 L_nxk0
    s_mov_b32 s11, s12
    s_mov_b32 s48, s52
    s_mov_b32 s49, s53
    s_mov_b32 s50, s54
    s_mov_b32 s54, 0
L_nxk0:
    s_and_b32 s10, s11, -8
    s_add_u32 s10, s10, s11
    s_add_u32 s10, s10, s86
    s_add_u32 s10, s10, s42
    s_sub_u32 s3, s10, 224
    s_cmp_ge_u32 s10, 224
    s_cselect_b32 s10, s3, s10
    s_mul_i32 s3, s11, s94
    s_add_u32 s3, s3, s87
    s_cmp_lt_u32 s11, 112
    s_cselect_b32 s10, s10, s3
    s_mul_i32 s10, s10, 6144
    s_waitcnt vmcnt(23)
    v_dot2_f32_bf16 v35, v32, v4, 0
    v_dot2_f32_bf16 v35, v33, v5, v35
    v_dot2_f32_bf16 v35, v34, v6, v35
    buffer_load_dwordx3 v[32:34], v1, s[48:51], s10 offen offset:0 nt
    s_waitcnt vmcnt(23)
    v_dot2_f32_bf16 v39, v36, v4, 0
    v_dot2_f32_bf16 v39, v37, v5, v39
    v_dot2_f32_bf16 v39, v38, v6, v39
    buffer_load_dwordx3 v[36:38], v1, s[48:51], s10 offen offset:768 nt
    s_waitcnt vmcnt(23)
    v_dot2_f32_bf16 v43, v40, v4, 0
    v_dot2_f32_bf16 v43, v41, v5, v43
    v_dot2_f32_bf16 v43, v42, v6, v43
    buffer_load_dwordx3 v[40:42], v1, s[48:51], s10 offen offset:1536 nt
    s_waitcnt vmcnt(23)
    v_dot2_f32_bf16 v47, v44, v4, 0
    v_dot2_f32_bf16 v47, v45, v5, v47
    v_dot2_f32_bf16 v47, v46, v6, v47
    buffer_load_dwordx3 v[44:46], v1, s[48:51], s10 offen offset:2304 nt
    s_waitcnt vmcnt(23)
    v_dot2_f32_bf16 v51, v48, v4, 0
    v_dot2_f32_bf16 v51, v49, v5, v51
    v_dot2_f32_bf16 v51, v50, v6, v51
    buffer_load_dwordx3 v[48:50], v1, s[48:51], s10 offen offset:3072 nt
    s_waitcnt vmcnt(23)
    v_dot2_f32_bf16 v55, v52, v4, 0
    v_dot2_f32_bf16 v55, v53, v5, v55
    v_dot2_f32_bf16 v55, v54, v6, v55
    buffer_load_dwordx3 v[52:54], v2, s[48:51], s10 offen offset:0 nt
    s_waitcnt vmcnt(23)
    v_dot2_f32_bf16 v59, v56, v4, 0
    v_dot2_f32_bf16 v59, v57, v5, v59
    v_dot2_f32_bf16 v59, v58, v6, v59
    buffer_load_dwordx3 v[56:58], v2, s[48:51], s10 offen offset:768 nt
    s_waitcnt vmcnt(23)
    v_dot2_f32_bf16 v63, v60, v4, 0
    v_dot2_f32_bf16 v63, v61, v5, v63
    v_dot2_f32_bf16 v63, v62, v6, v63
    buffer_load_dwordx3 v[60:62], v2, s[48:51], s10 offen offset:1536 nt
    v_add_f32_dpp v16, v35, v35 row_ror:8 row_mask:0xf bank_mask:0x3
    v_add_f32_dpp v17, v39, v39 row_ror:8 row_mask:0xf bank_mask:0x3
    v_add_f32_dpp v18, v43, v43 row_ror:8 row_mask:0xf bank_mask:0x3
    v_add_f32_dpp v19, v47, v47 row_ror:8 row_mask:0xf bank_mask:0x3
    v_add_f32_dpp v16, v51, v51 row_ror:8 row_mask:0xf bank_mask:0xc
    v_add_f32_dpp v17, v55, v55 row_ror:8 row_mask:0xf bank_mask:0xc
    v_add_f32_dpp v18, v59, v59 row_ror:8 row_mask:0xf bank_mask:0xc
    v_add_f32_dpp v19, v63, v63 row_ror:8 row_mask:0xf bank_mask:0xc
    v_add_f32_dpp v20, v16, v16 row_half_mirror row_mask:0xf bank_mask:0x5
    v_add_f32_dpp v21, v17, v17 row_half_mirror row_mask:0xf bank_mask:0x5
    s_nop 0
    v_add_f32_dpp v20, v18, v18 row_half_mirror row_mask:0xf bank_mask:0xa
    v_add_f32_dpp v21, v19, v19 row_half_mirror row_mask:0xf bank_mask:0xa
    s_nop 0
    v_add_f32_dpp v22, v20, v20 quad_perm:[2,3,0,1] row_mask:0xf bank_mask:0xf
    v_add_f32_dpp v23, v21, v21 quad_perm:[2,3,0,1] row_mask:0xf bank_mask:0xf
    v_cndmask_b32 v22, v22, v23, s[56:57]
    s_nop 1
    v_add_f32_dpp v22, v22, v22 quad_perm:[1,0,3,2] row_mask:0xf bank_mask:0xf
    v_mov_b32 v23, v22
    s_nop 1
    v_permlane16_swap_b32 v22, v23
    v_add_f32 v22, v22, v23
    v_cvt_pk_bf16_f32 v22, v22, v22
    v_lshlrev_b32 v22, 16, v22
    v_mul_f32 v22, s59, v22
    v_cvt_pk_bf16_f32 v22, v22, v22
    v_lshlrev_b32 v22, 16, v22
    ds_write_b32 v28, v22
    v_max_f32 v14, v14, v22
    v_add_u32 v28, 64, v28
    s_sub_u32 s13, s13, 1
    s_cmp_eq_u32 s13, 0
    s_cbranch_scc1 L_to1
    s_add_u32 s11, s11, 8
    s_cmp_ge_u32 s11, s63
    s_cbranch_scc0 L_nxk1
    s_mov_b32 s11, s12
    s_mov_b32 s48, s52
    s_mov_b32 s49, s53
    s_mov_b32 s50, s54
    s_mov_b32 s54, 0
L_nxk1:
    s_and_b32 s10, s11, -8
    s_add_u32 s10, s10, s11
    s_add_u32 s10, s10, s86
    s_add_u32 s10, s10, s42
    s_sub_u32 s3, s10, 224
    s_cmp_ge_u32 s10, 224
    s_cselect_b32 s10, s3, s10
    s_mul_i32 s3, s11, s94
    s_add_u32 s3, s3, s87
    s_cmp_lt_u32 s11, 112
    s_cselect_b32 s10, s10, s3
    s_mul_i32 s10, s10, 6144
    s_waitcnt vmcnt(23)
    v_dot2_f32_bf16 v67, v64, v4, 0
    v_dot2_f32_bf16 v67, v65, v5, v67
    v_dot2_f32_bf16 v67, v66, v6, v67
    buffer_load_dwordx3 v[64:66], v1, s[48:51], s10 offen offset:0 nt
    s_waitcnt vmcnt(23)
    v_dot2_f32_bf16 v71, v68, v4, 0
    v_dot2_f32_bf16 v71, v69, v5, v71
    v_dot2_f32_bf16 v71, v70, v6, v71
    buffer_load_dwordx3 v[68:70], v1, s[48:51], s10 offen offset:768 nt
    s_waitcnt vmcnt(23)
    v_dot2_f32_bf16 v75, v72, v4, 0
    v_dot2_f32_bf16 v75, v73, v5, v75
    v_dot2_f32_bf16 v75, v74, v6, v75
    buffer_load_dwordx3 v[72:74], v1, s[48:51], s10 offen offset:1536 nt
    s_waitcnt vmcnt(23)
    v_dot2_f32_bf16 v79, v76, v4, 0
    v_dot2_f32_bf16 v79, v77, v5, v79
    v_dot2_f32_bf16 v79, v78, v6, v79
    buffer_load_dwordx3 v[76:78], v1, s[48:51], s10 offen offset:2304 nt
    s_waitcnt vmcnt(23)
    v_dot2_f32_bf16 v83, v80, v4, 0
    v_dot2_f32_bf16 v83, v81, v5, v83
    v_dot2_f32_bf16 v83, v82, v6, v83
    buffer_load_dwordx3 v[80:82], v1, s[48:51], s10 offen offset:3072 nt
    s_waitcnt vmcnt(23)
    v_dot2_f32_bf16 v87, v84, v4, 0
    v_dot2_f32_bf16 v87, v85, v5, v87
    v_dot2_f32_bf16 v87, v86, v6, v87
    buffer_load_dwordx3 v[84:86], v2, s[48:51], s10 offen offset:0 nt
    s_waitcnt vmcnt(23)
    v_dot2_f32_bf16 v91, v88, v4, 0
    v_dot2_f32_bf16 v91, v89, v5, v91
    v_dot2_f32_bf16 v91, v90, v6, v91
    buffer_load_dwordx3 v[88:90], v2, s[48:51], s10 offen offset:768 nt
    s_waitcnt vmcnt(23)
    v_dot2_f32_bf16 v95, v92, v4, 0
    v_dot2_f32_bf16 v95, v93, v5, v95
    v_dot2_f32_bf16 v95, v94, v6, v95
    buffer_load_dwordx3 v[92:94], v2, s[48:51], s10 offen offset:1536 nt
    v_add_f32_dpp v16, v67, v67 row_ror:8 row_mask:0xf bank_mask:0x3
    v_add_f32_dpp v17, v71, v71 row_ror:8 row_mask:0xf bank_mask:0x3
    v_add_f32_dpp v18, v75, v75 row_ror:8 row_mask:0xf bank_mask:0x3
    v_add_f32_dpp v19, v79, v79 row_ror:8 row_mask:0xf bank_mask:0x3
    v_add_f32_dpp v16, v83, v83 row_ror:8 row_mask:0xf bank_mask:0xc
    v_add_f32_dpp v17, v87, v87 row_ror:8 row_mask:0xf bank_mask:0xc
    v_add_f32_dpp v18, v91, v91 row_ror:8 row_mask:0xf bank_mask:0xc
    v_add_f32_dpp v19, v95, v95 row_ror:8 row_mask:0xf bank_mask:0xc
    v_add_f32_dpp v20, v16, v16 row_half_mirror row_mask:0xf bank_mask:0x5
    v_add_f32_dpp v21, v17, v17 row_half_mirror row_mask:0xf bank_mask:0x5
    s_nop 0
    v_add_f32_dpp v20, v18, v18 row_half_mirror row_mask:0xf bank_mask:0xa
    v_add_f32_dpp v21, v19, v19 row_half_mirror row_mask:0xf bank_mask:0xa
    s_nop 0
    v_add_f32_dpp v22, v20, v20 quad_perm:[2,3,0,1] row_mask:0xf bank_mask:0xf
    v_add_f32_dpp v23, v21, v21 quad_perm:[2,3,0,1] row_mask:0xf bank_mask:0xf
    v_cndmask_b32 v22, v22, v23, s[56:57]
    s_nop 1
    v_add_f32_dpp v22, v22, v22 quad_perm:[1,0,3,2] row_mask:0xf bank_mask:0xf
    v_mov_b32 v23, v22
    s_nop 1
    v_permlane16_swap_b32 v22, v23
    v_add_f32 v22, v22, v23
    v_cvt_pk_bf16_f32 v22, v22, v22
    v_lshlrev_b32 v22, 16, v22
    v_mul_f32 v22, s59, v22
    v_cvt_pk_bf16_f32 v22, v22, v22
    v_lshlrev_b32 v22, 16, v22
    ds_write_b32 v28, v22
    v_max_f32 v14, v14, v22
    v_add_u32 v28, 64, v28
    s_sub_u32 s13, s13, 1
    s_cmp_eq_u32 s13, 0
    s_cbranch_scc1 L_to2
    s_add_u32 s11, s11, 8
    s_cmp_ge_u32 s11, s63
    s_cbranch_scc0 L_nxk2
    s_mov_b32 s11, s12
    s_mov_b32 s48, s52
    s_mov_b32 s49, s53
    s_mov_b32 s50, s54
    s_mov_b32 s54, 0
L_nxk2:
    s_and_b32 s10, s11, -8
    s_add_u32 s10, s10, s11
    s_add_u32 s10, s10, s86
    s_add_u32 s10, s10, s42
    s_sub_u32 s3, s10, 224
    s_cmp_ge_u32 s10, 224
    s_cselect_b32 s10, s3, s10
    s_mul_i32 s3, s11, s94
    s_add_u32 s3, s3, s87
    s_cmp_lt_u32 s11, 112
    s_cselect_b32 s10, s10, s3
    s_mul_i32 s10, s10, 6144
    s_waitcnt vmcnt(23)
    v_dot2_f32_bf16 v99, v96, v4, 0
    v_dot2_f32_bf16 v99, v97, v5, v99
    v_dot2_f32_bf16 v99, v98, v6, v99
    buffer_load_dwordx3 v[96:98], v1, s[48:51], s10 offen offset:0 nt
    s_waitcnt vmcnt(23)
    v_dot2_f32_bf16 v103, v100, v4, 0
    v_dot2_f32_bf16 v103, v101, v5, v103
    v_dot2_f32_bf16 v103, v102, v6, v103
    buffer_load_dwordx3 v[100:102], v1, s[48:51], s10 offen offset:768 nt
    s_waitcnt vmcnt(23)
    v_dot2_f32_bf16 v107, v104, v4, 0
    v_dot2_f32_bf16 v107, v105, v5, v107
    v_dot2_f32_bf16 v107, v106, v6, v107
    buffer_load_dwordx3 v[104:106], v1, s[48:51], s10 offen offset:1536 nt
    s_waitcnt vmcnt(23)
    v_dot2_f32_bf16 v111, v108, v4, 0
    v_dot2_f32_bf16 v111, v109, v5, v111
    v_dot2_f32_bf16 v111, v110, v6, v111
    buffer_load_dwordx3 v[108:110], v1, s[48:51], s10 offen offset:2304 nt
    s_waitcnt vmcnt(23)
    v_dot2_f32_bf16 v115, v112, v4, 0
    v_dot2_f32_bf16 v115, v113, v5, v115
    v_dot2_f32_bf16 v115, v114, v6, v115
    buffer_load_dwordx3 v[112:114], v1, s[48:51], s10 offen offset:3072 nt
    s_waitcnt vmcnt(23)
    v_dot2_f32_bf16 v119, v116, v4, 0
    v_dot2_f32_bf16 v119, v117, v5, v119
    v_dot2_f32_bf16 v119, v118, v6, v119
    buffer_load_dwordx3 v[116:118], v2, s[48:51], s10 offen offset:0 nt
    s_waitcnt vmcnt(23)
    v_dot2_f32_bf16 v123, v120, v4, 0
    v_dot2_f32_bf16 v123, v121, v5, v123
    v_dot2_f32_bf16 v123, v122, v6, v123
    buffer_load_dwordx3 v[120:122], v2, s[48:51], s10 offen offset:768 nt
    s_waitcnt vmcnt(23)
    v_dot2_f32_bf16 v127, v124, v4, 0
    v_dot2_f32_bf16 v127, v125, v5, v127
    v_dot2_f32_bf16 v127, v126, v6, v127
    buffer_load_dwordx3 v[124:126], v2, s[48:51], s10 offen offset:1536 nt
    v_add_f32_dpp v16, v99, v99 row_ror:8 row_mask:0xf bank_mask:0x3
    v_add_f32_dpp v17, v103, v103 row_ror:8 row_mask:0xf bank_mask:0x3
    v_add_f32_dpp v18, v107, v107 row_ror:8 row_mask:0xf bank_mask:0x3
    v_add_f32_dpp v19, v111, v111 row_ror:8 row_mask:0xf bank_mask:0x3
    v_add_f32_dpp v16, v115, v115 row_ror:8 row_mask:0xf bank_mask:0xc
    v_add_f32_dpp v17, v119, v119 row_ror:8 row_mask:0xf bank_mask:0xc
    v_add_f32_dpp v18, v123, v123 row_ror:8 row_mask:0xf bank_mask:0xc
    v_add_f32_dpp v19, v127, v127 row_ror:8 row_mask:0xf bank_mask:0xc
    v_add_f32_dpp v20, v16, v16 row_half_mirror row_mask:0xf bank_mask:0x5
    v_add_f32_dpp v21, v17, v17 row_half_mirror row_mask:0xf bank_mask:0x5
    s_nop 0
    v_add_f32_dpp v20, v18, v18 row_half_mirror row_mask:0xf bank_mask:0xa
    v_add_f32_dpp v21, v19, v19 row_half_mirror row_mask:0xf bank_mask:0xa
    s_nop 0
    v_add_f32_dpp v22, v20, v20 quad_perm:[2,3,0,1] row_mask:0xf bank_mask:0xf
    v_add_f32_dpp v23, v21, v21 quad_perm:[2,3,0,1] row_mask:0xf bank_mask:0xf
    v_cndmask_b32 v22, v22, v23, s[56:57]
    s_nop 1
    v_add_f32_dpp v22, v22, v22 quad_perm:[1,0,3,2] row_mask:0xf bank_mask:0xf
    v_mov_b32 v23, v22
    s_nop 1
    v_permlane16_swap_b32 v22, v23
    v_add_f32 v22, v22, v23
    v_cvt_pk_bf16_f32 v22, v22, v22
    v_lshlrev_b32 v22, 16, v22
    v_mul_f32 v22, s59, v22
    v_cvt_pk_bf16_f32 v22, v22, v22
    v_lshlrev_b32 v22, 16, v22
    ds_write_b32 v28, v22
    v_max_f32 v14, v14, v22
    v_add_u32 v28, 64, v28
    s_sub_u32 s13, s13, 1
    s_cmp_eq_u32 s13, 0
    s_cbranch_scc0 L_k0
    v_max_f32_dpp v14, v14, v14 quad_perm:[2,3,0,1] row_mask:0xf bank_mask:0xf
    s_nop 1
    v_max_f32_dpp v14, v14, v14 row_half_mirror row_mask:0xf bank_mask:0xf
    s_nop 1
    v_max_f32_dpp v14, v14, v14 row_ror:8 row_mask:0xf bank_mask:0xf
    v_mov_b32 v25, v14
    s_nop 1
    v_permlane32_swap_b32 v14, v25
    v_max_f32 v14, v14, v25
    v_mul_f32 v31, 0.5, v14
    s_mov_b32 s13, s15
    v_mov_b32 v25, 28
    s_mov_b64 exec, 1
    ds_add_u32 v25, v30
    s_mov_b64 exec, -1
L_v0:
    ds_read_b32 v22, v29
    v_add_u32 v29, 64, v29
    s_add_u32 s11, s11, 8
    s_cmp_ge_u32 s11, s63
    s_cbranch_scc0 L_nxv0
    s_mov_b32 s11, s12
    s_mov_b32 s48, s52
    s_mov_b32 s49, s53
    s_mov_b32 s50, s54
    s_mov_b32 s54, 0
L_nxv0:
    s_and_b32 s10, s11, -8
    s_add_u32 s10, s10, s11
    s_add_u32 s10, s10, s86
    s_add_u32 s10, s10, s42
    s_sub_u32 s3, s10, 224
    s_cmp_ge_u32 s10, 224
    s_cselect_b32 s10, s3, s10
    s_mul_i32 s3, s11, s94
    s_add_u32 s3, s3, s87
    s_cmp_lt_u32 s11, 112
    s_cselect_b32 s10, s10, s3
    s_mul_i32 s10, s10, 6144
    s_waitcnt lgkmcnt(0)
    v_sub_f32 v22, v22, v14
    v_mul_f32 v22, s58, v22
    v_exp_f32 v22, v22
    s_nop 0
    v_cvt_pk_bf16_f32 v26, v22, 0
    v_cvt_pk_bf16_f32 v27, 0, v22
    v_add_f32_dpp v22, v22, v22 quad_perm:[2,3,0,1] row_mask:0xf bank_mask:0xf
    s_nop 1
    v_add_f32_dpp v22, v22, v22 row_half_mirror row_mask:0xf bank_mask:0xf
    s_nop 1
    v_add_f32_dpp v22, v22, v22 row_ror:8 row_mask:0xf bank_mask:0xf
    v_add_f32 v15, v15, v22
    s_waitcnt vmcnt(23)
    v_dot2c_f32_bf16_dpp v8, v26, v32 row_newbcast:0 row_mask:0xf bank_mask:0xf
    v_dot2c_f32_bf16_dpp v9, v27, v32 row_newbcast:0 row_mask:0xf bank_mask:0xf
    v_dot2c_f32_bf16_dpp v10, v26, v33 row_newbcast:0 row_mask:0xf bank_mask:0xf
    v_dot2c_f32_bf16_dpp v11, v27, v33 row_newbcast:0 row_mask:0xf bank_mask:0xf
    v_dot2c_f32_bf16_dpp v12, v26, v34 row_newbcast:0 row_mask:0xf bank_mask:0xf
    v_dot2c_f32_bf16_dpp v13, v27, v34 row_newbcast:0 row_mask:0xf bank_mask:0xf
    buffer_load_dwordx3 v[32:34], v1, s[48:51], s10 offen offset:0 nt
    s_waitcnt vmcnt(23)
    v_dot2c_f32_bf16_dpp v8, v26, v36 row_newbcast:2 row_mask:0xf bank_mask:0xf
    v_dot2c_f32_bf16_dpp v9, v27, v36 row_newbcast:2 row_mask:0xf bank_mask:0xf
    v_dot2c_f32_bf16_dpp v10, v26, v37 row_newbcast:2 row_mask:0xf bank_mask:0xf
    v_dot2c_f32_bf16_dpp v11, v27, v37 row_newbcast:2 row_mask:0xf bank_mask:0xf
    v_dot2c_f32_bf16_dpp v12, v26, v38 row_newbcast:2 row_mask:0xf bank_mask:0xf
    v_dot2c_f32_bf16_dpp v13, v27, v38 row_newbcast:2 row_mask:0xf bank_mask:0xf
    buffer_load_dwordx3 v[36:38], v1, s[48:51], s10 offen offset:768 nt
    s_waitcnt vmcnt(23)
    v_dot2c_f32_bf16_dpp v8, v26, v40 row_newbcast:4 row_mask:0xf bank_mask:0xf
    v_dot2c_f32_bf16_dpp v9, v27, v40 row_newbcast:4 row_mask:0xf bank_mask:0xf
    v_dot2c_f32_bf16_dpp v10, v26, v41 row_newbcast:4 row_mask:0xf bank_mask:0xf
    v_dot2c_f32_bf16_dpp v11, v27, v41 row_newbcast:4 row_mask:0xf bank_mask:0xf
    v_dot2c_f32_bf16_dpp v12, v26, v42 row_newbcast:4 row_mask:0xf bank_mask:0xf
    v_dot2c_f32_bf16_dpp v13, v27, v42 row_newbcast:4 row_mask:0xf bank_mask:0xf
    buffer_load_dwordx3 v[40:42], v1, s[48:51], s10 offen offset:1536 nt
    s_waitcnt vmcnt(23)
    v_dot2c_f32_bf16_dpp v8, v26, v44 row_newbcast:6 row_mask:0xf bank_mask:0xf
    v_dot2c_f32_bf16_dpp v9, v27, v44 row_newbcast:6 row_mask:0xf bank_mask:0xf
    v_dot2c_f32_bf16_dpp v10, v26, v45 row_newbcast:6 row_mask:0xf bank_mask:0xf
    v_dot2c_f32_bf16_dpp v11, v27, v45 row_newbcast:6 row_mask:0xf bank_mask:0xf
    v_dot2c_f32_bf16_dpp v12, v26, v46 row_newbcast:6 row_mask:0xf bank_mask:0xf
    v_dot2c_f32_bf16_dpp v13, v27, v46 row_newbcast:6 row_mask:0xf bank_mask:0xf
    buffer_load_dwordx3 v[44:46], v1, s[48:51], s10 offen offset:2304 nt
    s_waitcnt vmcnt(23)
    v_dot2c_f32_bf16_dpp v8, v26, v48 row_newbcast:8 row_mask:0xf bank_mask:0xf
    v_dot2c_f32_bf16_dpp v9, v27, v48 row_newbcast:8 row_mask:0xf bank_mask:0xf
    v_dot2c_f32_bf16_dpp v10, v26, v49 row_newbcast:8 row_mask:0xf bank_mask:0xf
    v_dot2c_f32_bf16_dpp v11, v27, v49 row_newbcast:8 row_mask:0xf bank_mask:0xf
    v_dot2c_f32_bf16_dpp v12, v26, v50 row_newbcast:8 row_mask:0xf bank_mask:0xf
    v_dot2c_f32_bf16_dpp v13, v27, v50 row_newbcast:8 row_mask:0xf bank_mask:0xf
    buffer_load_dwordx3 v[48:50], v1, s[48:51], s10 offen offset:3072 nt
    s_waitcnt vmcnt(23)
    v_dot2c_f32_bf16_dpp v8, v26, v52 row_newbcast:10 row_mask:0xf bank_mask:0xf
    v_dot2c_f32_bf16_dpp v9, v27, v52 row_newbcast:10 row_mask:0xf bank_mask:0xf
    v_dot2c_f32_bf16_dpp v10, v26, v53 row_newbcast:10 row_mask:0xf bank_mask:0xf
    v_dot2c_f32_bf16_dpp v11, v27, v53 row_newbcast:10 row_mask:0xf bank_mask:0xf
    v_dot2c_f32_bf16_dpp v12, v26, v54 row_newbcast:10 row_mask:0xf bank_mask:0xf
    v_dot2c_f32_bf16_dpp v13, v27, v54 row_newbcast:10 row_mask:0xf bank_mask:0xf
    buffer_load_dwordx3 v[52:54], v2, s[48:51], s10 offen offset:0 nt
    s_waitcnt vmcnt(23)
    v_dot2c_f32_bf16_dpp v8, v26, v56 row_newbcast:12 row_mask:0xf bank_mask:0xf
    v_dot2c_f32_bf16_dpp v9, v27, v56 row_newbcast:12 row_mask:0xf bank_mask:0xf
    v_dot2c_f32_bf16_dpp v10, v26, v57 row_newbcast:12 row_mask:0xf bank_mask:0xf
    v_dot2c_f32_bf16_dpp v11, v27, v57 row_newbcast:12 row_mask:0xf bank_mask:0xf
    v_dot2c_f32_bf16_dpp v12, v26, v58 row_newbcast:12 row_mask:0xf bank_mask:0xf
    v_dot2c_f32_bf16_dpp v13, v27, v58 row_newbcast:12 row_mask:0xf bank_mask:0xf
    buffer_load_dwordx3 v[56:58], v2, s[48:51], s10 offen offset:768 nt
    s_waitcnt vmcnt(23)
    v_dot2c_f32_bf16_dpp v8, v26, v60 row_newbcast:14 row_mask:0xf bank_mask:0xf
    v_dot2c_f32_bf16_dpp v9, v27, v60 row_newbcast:14 row_mask:0xf bank_mask:0xf
    v_dot2c_f32_bf16_dpp v10, v26, v61 row_newbcast:14 row_mask:0xf bank_mask:0xf
    v_dot2c_f32_bf16_dpp v11, v27, v61 row_newbcast:14 row_mask:0xf bank_mask:0xf
    v_dot2c_f32_bf16_dpp v12, v26, v62 row_newbcast:14 row_mask:0xf bank_mask:0xf
    v_dot2c_f32_bf16_dpp v13, v27, v62 row_newbcast:14 row_mask:0xf bank_mask:0xf
    buffer_load_dwordx3 v[60:62], v2, s[48:51], s10 offen offset:1536 nt
    s_sub_u32 s13, s13, 1
    s_cmp_eq_u32 s13, 0
    s_cbranch_scc1 L_done
L_v1:
    ds_read_b32 v22, v29
    v_add_u32 v29, 64, v29
    s_add_u32 s11, s11, 8
    s_cmp_ge_u32 s11, s63
    s_cbranch_scc0 L_nxv1
    s_mov_b32 s11, s12
    s_mov_b32 s48, s52
    s_mov_b32 s49, s53
    s_mov_b32 s50, s54
    s_mov_b32 s54, 0
L_nxv1:
    s_and_b32 s10, s11, -8
    s_add_u32 s10, s10, s11
    s_add_u32 s10, s10, s86
    s_add_u32 s10, s10, s42
    s_sub_u32 s3, s10, 224
    s_cmp_ge_u32 s10, 224
    s_cselect_b32 s10, s3, s10
    s_mul_i32 s3, s11, s94
    s_add_u32 s3, s3, s87
    s_cmp_lt_u32 s11, 112
    s_cselect_b32 s10, s10, s3
    s_mul_i32 s10, s10, 6144
    s_waitcnt lgkmcnt(0)
    v_sub_f32 v22, v22, v14
    v_mul_f32 v22, s58, v22
    v_exp_f32 v22, v22
    s_nop 0
    v_cvt_pk_bf16_f32 v26, v22, 0
    v_cvt_pk_bf16_f32 v27, 0, v22
    v_add_f32_dpp v22, v22, v22 quad_perm:[2,3,0,1] row_mask:0xf bank_mask:0xf
    s_nop 1
    v_add_f32_dpp v22, v22, v22 row_half_mirror row_mask:0xf bank_mask:0xf
    s_nop 1
    v_add_f32_dpp v22, v22, v22 row_ror:8 row_mask:0xf bank_mask:0xf
    v_add_f32 v15, v15, v22
    s_waitcnt vmcnt(23)
    v_dot2c_f32_bf16_dpp v8, v26, v64 row_newbcast:0 row_mask:0xf bank_mask:0xf
    v_dot2c_f32_bf16_dpp v9, v27, v64 row_newbcast:0 row_mask:0xf bank_mask:0xf
    v_dot2c_f32_bf16_dpp v10, v26, v65 row_newbcast:0 row_mask:0xf bank_mask:0xf
    v_dot2c_f32_bf16_dpp v11, v27, v65 row_newbcast:0 row_mask:0xf bank_mask:0xf
    v_dot2c_f32_bf16_dpp v12, v26, v66 row_newbcast:0 row_mask:0xf bank_mask:0xf
    v_dot2c_f32_bf16_dpp v13, v27, v66 row_newbcast:0 row_mask:0xf bank_mask:0xf
    buffer_load_dwordx3 v[64:66], v1, s[48:51], s10 offen offset:0 nt
    s_waitcnt vmcnt(23)
    v_dot2c_f32_bf16_dpp v8, v26, v68 row_newbcast:2 row_mask:0xf bank_mask:0xf
    v_dot2c_f32_bf16_dpp v9, v27, v68 row_newbcast:2 row_mask:0xf bank_mask:0xf
    v_dot2c_f32_bf16_dpp v10, v26, v69 row_newbcast:2 row_mask:0xf bank_mask:0xf
    v_dot2c_f32_bf16_dpp v11, v27, v69 row_newbcast:2 row_mask:0xf bank_mask:0xf
    v_dot2c_f32_bf16_dpp v12, v26, v70 row_newbcast:2 row_mask:0xf bank_mask:0xf
    v_dot2c_f32_bf16_dpp v13, v27, v70 row_newbcast:2 row_mask:0xf bank_mask:0xf
    buffer_load_dwordx3 v[68:70], v1, s[48:51], s10 offen offset:768 nt
    s_waitcnt vmcnt(23)
    v_dot2c_f32_bf16_dpp v8, v26, v72 row_newbcast:4 row_mask:0xf bank_mask:0xf
    v_dot2c_f32_bf16_dpp v9, v27, v72 row_newbcast:4 row_mask:0xf bank_mask:0xf
    v_dot2c_f32_bf16_dpp v10, v26, v73 row_newbcast:4 row_mask:0xf bank_mask:0xf
    v_dot2c_f32_bf16_dpp v11, v27, v73 row_newbcast:4 row_mask:0xf bank_mask:0xf
    v_dot2c_f32_bf16_dpp v12, v26, v74 row_newbcast:4 row_mask:0xf bank_mask:0xf
    v_dot2c_f32_bf16_dpp v13, v27, v74 row_newbcast:4 row_mask:0xf bank_mask:0xf
    buffer_load_dwordx3 v[72:74], v1, s[48:51], s10 offen offset:1536 nt
    s_waitcnt vmcnt(23)
    v_dot2c_f32_bf16_dpp v8, v26, v76 row_newbcast:6 row_mask:0xf bank_mask:0xf
    v_dot2c_f32_bf16_dpp v9, v27, v76 row_newbcast:6 row_mask:0xf bank_mask:0xf
    v_dot2c_f32_bf16_dpp v10, v26, v77 row_newbcast:6 row_mask:0xf bank_mask:0xf
    v_dot2c_f32_bf16_dpp v11, v27, v77 row_newbcast:6 row_mask:0xf bank_mask:0xf
    v_dot2c_f32_bf16_dpp v12, v26, v78 row_newbcast:6 row_mask:0xf bank_mask:0xf
    v_dot2c_f32_bf16_dpp v13, v27, v78 row_newbcast:6 row_mask:0xf bank_mask:0xf
    buffer_load_dwordx3 v[76:78], v1, s[48:51], s10 offen offset:2304 nt
    s_waitcnt vmcnt(23)
    v_dot2c_f32_bf16_dpp v8, v26, v80 row_newbcast:8 row_mask:0xf bank_mask:0xf
    v_dot2c_f32_bf16_dpp v9, v27, v80 row_newbcast:8 row_mask:0xf bank_mask:0xf
    v_dot2c_f32_bf16_dpp v10, v26, v81 row_newbcast:8 row_mask:0xf bank_mask:0xf
    v_dot2c_f32_bf16_dpp v11, v27, v81 row_newbcast:8 row_mask:0xf bank_mask:0xf
    v_dot2c_f32_bf16_dpp v12, v26, v82 row_newbcast:8 row_mask:0xf bank_mask:0xf
    v_dot2c_f32_bf16_dpp v13, v27, v82 row_newbcast:8 row_mask:0xf bank_mask:0xf
    buffer_load_dwordx3 v[80:82], v1, s[48:51], s10 offen offset:3072 nt
    s_waitcnt vmcnt(23)
    v_dot2c_f32_bf16_dpp v8, v26, v84 row_newbcast:10 row_mask:0xf bank_mask:0xf
    v_dot2c_f32_bf16_dpp v9, v27, v84 row_newbcast:10 row_mask:0xf bank_mask:0xf
    v_dot2c_f32_bf16_dpp v10, v26, v85 row_newbcast:10 row_mask:0xf bank_mask:0xf
    v_dot2c_f32_bf16_dpp v11, v27, v85 row_newbcast:10 row_mask:0xf bank_mask:0xf
    v_dot2c_f32_bf16_dpp v12, v26, v86 row_newbcast:10 row_mask:0xf bank_mask:0xf
    v_dot2c_f32_bf16_dpp v13, v27, v86 row_newbcast:10 row_mask:0xf bank_mask:0xf
    buffer_load_dwordx3 v[84:86], v2, s[48:51], s10 offen offset:0 nt
    s_waitcnt vmcnt(23)
    v_dot2c_f32_bf16_dpp v8, v26, v88 row_newbcast:12 row_mask:0xf bank_mask:0xf
    v_dot2c_f32_bf16_dpp v9, v27, v88 row_newbcast:12 row_mask:0xf bank_mask:0xf
    v_dot2c_f32_bf16_dpp v10, v26, v89 row_newbcast:12 row_mask:0xf bank_mask:0xf
    v_dot2c_f32_bf16_dpp v11, v27, v89 row_newbcast:12 row_mask:0xf bank_mask:0xf
    v_dot2c_f32_bf16_dpp v12, v26, v90 row_newbcast:12 row_mask:0xf bank_mask:0xf
    v_dot2c_f32_bf16_dpp v13, v27, v90 row_newbcast:12 row_mask:0xf bank_mask:0xf
    buffer_load_dwordx3 v[88:90], v2, s[48:51], s10 offen offset:768 nt
    s_waitcnt vmcnt(23)
    v_dot2c_f32_bf16_dpp v8, v26, v92 row_newbcast:14 row_mask:0xf bank_mask:0xf
    v_dot2c_f32_bf16_dpp v9, v27, v92 row_newbcast:14 row_mask:0xf bank_mask:0xf
    v_dot2c_f32_bf16_dpp v10, v26, v93 row_newbcast:14 row_mask:0xf bank_mask:0xf
    v_dot2c_f32_bf16_dpp v11, v27, v93 row_newbcast:14 row_mask:0xf bank_mask:0xf
    v_dot2c_f32_bf16_dpp v12, v26, v94 row_newbcast:14 row_mask:0xf bank_mask:0xf
    v_dot2c_f32_bf16_dpp v13, v27, v94 row_newbcast:14 row_mask:0xf bank_mask:0xf
    buffer_load_dwordx3 v[92:94], v2, s[48:51], s10 offen offset:1536 nt
    s_sub_u32 s13, s13, 1
    s_cmp_eq_u32 s13, 0
    s_cbranch_scc1 L_done
L_v2:
    ds_read_b32 v22, v29
    v_add_u32 v29, 64, v29
    s_add_u32 s11, s11, 8
    s_cmp_ge_u32 s11, s63
    s_cbranch_scc0 L_nxv2
    s_mov_b32 s11, s12
    s_mov_b32 s48, s52
    s_mov_b32 s49, s53
    s_mov_b32 s50, s54
    s_mov_b32 s54, 0
L_nxv2:
    s_and_b32 s10, s11, -8
    s_add_u32 s10, s10, s11
    s_add_u32 s10, s10, s86
    s_add_u32 s10, s10, s42
    s_sub_u32 s3, s10, 224
    s_cmp_ge_u32 s10, 224
    s_cselect_b32 s10, s3, s10
    s_mul_i32 s3, s11, s94
    s_add_u32 s3, s3, s87
    s_cmp_lt_u32 s11, 112
    s_cselect_b32 s10, s10, s3
    s_mul_i32 s10, s10, 6144
    s_waitcnt lgkmcnt(0)
    v_sub_f32 v22, v22, v14
    v_mul_f32 v22, s58, v22
    v_exp_f32 v22, v22
    s_nop 0
    v_cvt_pk_bf16_f32 v26, v22, 0
    v_cvt_pk_bf16_f32 v27, 0, v22
    v_add_f32_dpp v22, v22, v22 quad_perm:[2,3,0,1] row_mask:0xf bank_mask:0xf
    s_nop 1
    v_add_f32_dpp v22, v22, v22 row_half_mirror row_mask:0xf bank_mask:0xf
    s_nop 1
    v_add_f32_dpp v22, v22, v22 row_ror:8 row_mask:0xf bank_mask:0xf
    v_add_f32 v15, v15, v22
    s_waitcnt vmcnt(23)
    v_dot2c_f32_bf16_dpp v8, v26, v96 row_newbcast:0 row_mask:0xf bank_mask:0xf
    v_dot2c_f32_bf16_dpp v9, v27, v96 row_newbcast:0 row_mask:0xf bank_mask:0xf
    v_dot2c_f32_bf16_dpp v10, v26, v97 row_newbcast:0 row_mask:0xf bank_mask:0xf
    v_dot2c_f32_bf16_dpp v11, v27, v97 row_newbcast:0 row_mask:0xf bank_mask:0xf
    v_dot2c_f32_bf16_dpp v12, v26, v98 row_newbcast:0 row_mask:0xf bank_mask:0xf
    v_dot2c_f32_bf16_dpp v13, v27, v98 row_newbcast:0 row_mask:0xf bank_mask:0xf
    buffer_load_dwordx3 v[96:98], v1, s[48:51], s10 offen offset:0 nt
    s_waitcnt vmcnt(23)
    v_dot2c_f32_bf16_dpp v8, v26, v100 row_newbcast:2 row_mask:0xf bank_mask:0xf
    v_dot2c_f32_bf16_dpp v9, v27, v100 row_newbcast:2 row_mask:0xf bank_mask:0xf
    v_dot2c_f32_bf16_dpp v10, v26, v101 row_newbcast:2 row_mask:0xf bank_mask:0xf
    v_dot2c_f32_bf16_dpp v11, v27, v101 row_newbcast:2 row_mask:0xf bank_mask:0xf
    v_dot2c_f32_bf16_dpp v12, v26, v102 row_newbcast:2 row_mask:0xf bank_mask:0xf
    v_dot2c_f32_bf16_dpp v13, v27, v102 row_newbcast:2 row_mask:0xf bank_mask:0xf
    buffer_load_dwordx3 v[100:102], v1, s[48:51], s10 offen offset:768 nt
    s_waitcnt vmcnt(23)
    v_dot2c_f32_bf16_dpp v8, v26, v104 row_newbcast:4 row_mask:0xf bank_mask:0xf
    v_dot2c_f32_bf16_dpp v9, v27, v104 row_newbcast:4 row_mask:0xf bank_mask:0xf
    v_dot2c_f32_bf16_dpp v10, v26, v105 row_newbcast:4 row_mask:0xf bank_mask:0xf
    v_dot2c_f32_bf16_dpp v11, v27, v105 row_newbcast:4 row_mask:0xf bank_mask:0xf
    v_dot2c_f32_bf16_dpp v12, v26, v106 row_newbcast:4 row_mask:0xf bank_mask:0xf
    v_dot2c_f32_bf16_dpp v13, v27, v106 row_newbcast:4 row_mask:0xf bank_mask:0xf
    buffer_load_dwordx3 v[104:106], v1, s[48:51], s10 offen offset:1536 nt
    s_waitcnt vmcnt(23)
    v_dot2c_f32_bf16_dpp v8, v26, v108 row_newbcast:6 row_mask:0xf bank_mask:0xf
    v_dot2c_f32_bf16_dpp v9, v27, v108 row_newbcast:6 row_mask:0xf bank_mask:0xf
    v_dot2c_f32_bf16_dpp v10, v26, v109 row_newbcast:6 row_mask:0xf bank_mask:0xf
    v_dot2c_f32_bf16_dpp v11, v27, v109 row_newbcast:6 row_mask:0xf bank_mask:0xf
    v_dot2c_f32_bf16_dpp v12, v26, v110 row_newbcast:6 row_mask:0xf bank_mask:0xf
    v_dot2c_f32_bf16_dpp v13, v27, v110 row_newbcast:6 row_mask:0xf bank_mask:0xf
    buffer_load_dwordx3 v[108:110], v1, s[48:51], s10 offen offset:2304 nt
    s_waitcnt vmcnt(23)
    v_dot2c_f32_bf16_dpp v8, v26, v112 row_newbcast:8 row_mask:0xf bank_mask:0xf
    v_dot2c_f32_bf16_dpp v9, v27, v112 row_newbcast:8 row_mask:0xf bank_mask:0xf
    v_dot2c_f32_bf16_dpp v10, v26, v113 row_newbcast:8 row_mask:0xf bank_mask:0xf
    v_dot2c_f32_bf16_dpp v11, v27, v113 row_newbcast:8 row_mask:0xf bank_mask:0xf
    v_dot2c_f32_bf16_dpp v12, v26, v114 row_newbcast:8 row_mask:0xf bank_mask:0xf
    v_dot2c_f32_bf16_dpp v13, v27, v114 row_newbcast:8 row_mask:0xf bank_mask:0xf
    buffer_load_dwordx3 v[112:114], v1, s[48:51], s10 offen offset:3072 nt
    s_waitcnt vmcnt(23)
    v_dot2c_f32_bf16_dpp v8, v26, v116 row_newbcast:10 row_mask:0xf bank_mask:0xf
    v_dot2c_f32_bf16_dpp v9, v27, v116 row_newbcast:10 row_mask:0xf bank_mask:0xf
    v_dot2c_f32_bf16_dpp v10, v26, v117 row_newbcast:10 row_mask:0xf bank_mask:0xf
    v_dot2c_f32_bf16_dpp v11, v27, v117 row_newbcast:10 row_mask:0xf bank_mask:0xf
    v_dot2c_f32_bf16_dpp v12, v26, v118 row_newbcast:10 row_mask:0xf bank_mask:0xf
    v_dot2c_f32_bf16_dpp v13, v27, v118 row_newbcast:10 row_mask:0xf bank_mask:0xf
    buffer_load_dwordx3 v[116:118], v2, s[48:51], s10 offen offset:0 nt
    s_waitcnt vmcnt(23)
    v_dot2c_f32_bf16_dpp v8, v26, v120 row_newbcast:12 row_mask:0xf bank_mask:0xf
    v_dot2c_f32_bf16_dpp v9, v27, v120 row_newbcast:12 row_mask:0xf bank_mask:0xf
    v_dot2c_f32_bf16_dpp v10, v26, v121 row_newbcast:12 row_mask:0xf bank_mask:0xf
    v_dot2c_f32_bf16_dpp v11, v27, v121 row_newbcast:12 row_mask:0xf bank_mask:0xf
    v_dot2c_f32_bf16_dpp v12, v26, v122 row_newbcast:12 row_mask:0xf bank_mask:0xf
    v_dot2c_f32_bf16_dpp v13, v27, v122 row_newbcast:12 row_mask:0xf bank_mask:0xf
    buffer_load_dwordx3 v[120:122], v2, s[48:51], s10 offen offset:768 nt
    s_waitcnt vmcnt(23)
    v_dot2c_f32_bf16_dpp v8, v26, v124 row_newbcast:14 row_mask:0xf bank_mask:0xf
    v_dot2c_f32_bf16_dpp v9, v27, v124 row_newbcast:14 row_mask:0xf bank_mask:0xf
    v_dot2c_f32_bf16_dpp v10, v26, v125 row_newbcast:14 row_mask:0xf bank_mask:0xf
    v_dot2c_f32_bf16_dpp v11, v27, v125 row_newbcast:14 row_mask:0xf bank_mask:0xf
    v_dot2c_f32_bf16_dpp v12, v26, v126 row_newbcast:14 row_mask:0xf bank_mask:0xf
    v_dot2c_f32_bf16_dpp v13, v27, v126 row_newbcast:14 row_mask:0xf bank_mask:0xf
    buffer_load_dwordx3 v[124:126], v2, s[48:51], s10 offen offset:1536 nt
    s_sub_u32 s13, s13, 1
    s_cmp_eq_u32 s13, 0
    s_cbranch_scc0 L_v0
L_done:
    v_permlane32_swap_b32 v15, v31
    v_permlane32_swap_b32 v8, v9
    v_permlane32_swap_b32 v10, v11
    v_permlane32_swap_b32 v12, v13
    v_add_f32 v23, v15, v31
    v_add_f32 v20, v8, v9
    v_add_f32 v21, v10, v11
    v_add_f32 v22, v12, v13
    ds_write_b128 v7, v[20:23]
    s_waitcnt lgkmcnt(0)
    s_barrier
    s_endpgm
L_to1:
    v_max_f32_dpp v14, v14, v14 quad_perm:[2,3,0,1] row_mask:0xf bank_mask:0xf
    s_nop 1
    v_max_f32_dpp v14, v14, v14 row_half_mirror row_mask:0xf bank_mask:0xf
    s_nop 1
    v_max_f32_dpp v14, v14, v14 row_ror:8 row_mask:0xf bank_mask:0xf
    v_mov_b32 v25, v14
    s_nop 1
    v_permlane32_swap_b32 v14, v25
    v_max_f32 v14, v14, v25
    v_mul_f32 v31, 0.5, v14
    s_mov_b32 s13, s15
    v_mov_b32 v25, 28
    s_mov_b64 exec, 1
    ds_add_u32 v25, v30
    s_mov_b64 exec, -1
    s_branch L_v1
L_to2:
    v_max_f32_dpp v14, v14, v14 quad_perm:[2,3,0,1] row_mask:0xf bank_mask:0xf
    s_nop 1
    v_max_f32_dpp v14, v14, v14 row_half_mirror row_mask:0xf bank_mask:0xf
    s_nop 1
    v_max_f32_dpp v14, v14, v14 row_ror:8 row_mask:0xf bank_mask:0xf
    v_mov_b32 v25, v14
    s_nop 1
    v_permlane32_swap_b32 v14, v25
    v_max_f32 v14, v14, v25
    v_mul_f32 v31, 0.5, v14
    s_mov_b32 s13, s15
    v_mov_b32 v25, 28
    s_mov_b64 exec, 1
    ds_add_u32 v25, v30
    s_mov_b64 exec, -1
    s_branch L_v2
L_service:
    s_setprio 2
    v_and_b32 v4, 3, v0
    v_bfe_u32 v5, v0, 2, 2
    v_lshrrev_b32 v6, 4, v0
    v_mov_b32 v15, 0
    v_mov_b32 v10, 0
    v_mov_b32 v11, 1
    v_lshlrev_b32 v1, 4, v0
    s_cmp_eq_u32 s4, 0
    s_cbranch_scc0 L_nozero
    ds_write_b32 v10, v10 offset:0
    ds_write_b32 v10, v10 offset:4
    ds_write_b32 v10, v10 offset:8
    ds_write_b32 v10, v10 offset:12
    ds_write_b32 v10, v10 offset:20
    ds_write_b32 v10, v10 offset:24
    ds_write_b32 v10, v10 offset:28
    ds_write_b32 v10, v10 offset:32
L_nozero:
    s_lshl_b32 s62, s4, 14
    s_add_u32 s62, s62, 50176
    s_waitcnt lgkmcnt(0)
    s_load_dword s9, s[40:41], 0
    s_cmp_gt_u32 s60, 1
    s_cbranch_scc1 L_nojob
    v_mul_u32_u24 v7, 1280, v4
    v_lshl_add_u32 v7, v5, 6, v7
    v_lshl_add_u32 v7, v6, 4, v7
    s_lshl_b32 s3, s4, 8
    s_cmp_eq_u32 s60, 0
    s_cbranch_scc0 L_modjob
    s_mov_b32 s52, s16
    s_mov_b32 s53, s17
    s_mov_b32 s54, 5120
    s_mov_b32 s55, 0x20000
    s_mov_b32 s48, s22
    s_mov_b32 s49, s23
    s_mov_b32 s50, 7864320
    s_mov_b32 s51, 0x20000
    s_mov_b32 s42, 12288
    s_mov_b32 s59, s61
    s_mul_i32 s13, s5, 12
    s_add_u32 s61, s61, s13
    s_lshl_b32 s13, s61, 7
    s_branch L_dojob
L_modjob:
    s_mov_b32 s52, s34
    s_mov_b32 s53, s35
    s_mov_b32 s54, 5120
    s_mov_b32 s55, 0x20000
    buffer_load_dwordx4 v[36:39], v7, s[52:55], s3 offen
    s_mov_b32 s54, 0
    s_mov_b32 s48, s36
    s_mov_b32 s49, s37
    s_mov_b32 s50, 4915200
    s_mov_b32 s51, 0x20000
    s_mov_b32 s42, 7680
    s_lshl_b32 s13, s61, 7
L_dojob:
    v_lshrrev_b32 v8, 3, v0
    s_lshl_b32 s3, s4, 7
    v_add_u32 v8, s3, v8
    v_mul_lo_u32 v8, v8, s42
    v_and_b32 v9, 7, v0
    v_lshlrev_b32 v9, 4, v9
    v_and_b32 v12, 1, v6
    v_lshlrev_b32 v12, 5, v12
    v_xor_b32 v9, v9, v12
    v_add_u32 v8, v8, v9
    s_lshl_b32 s42, s42, 3
    s_mov_b32 m0, s62
    s_mov_b32 s3, 4
L_dma0:
    buffer_load_dwordx4 v8, s[48:51], s13 offen  lds
    v_xor_b32 v8, 64, v8
    s_add_u32 m0, m0, 1024
    s_add_u32 s13, s13, s42
    s_sub_u32 s3, s3, 1
    s_cmp_lg_u32 s3, 0
    s_cbranch_scc1 L_dma0
    buffer_load_dwordx4 v[20:23], v7, s[52:55], 0 offen offset:0
    buffer_load_dwordx4 v[24:27], v7, s[52:55], 0 offen offset:256
    buffer_load_dwordx4 v[28:31], v7, s[52:55], 0 offen offset:512
    buffer_load_dwordx4 v[32:35], v7, s[52:55], 0 offen offset:768
    buffer_load_dwordx4 v[60:63], v7, s[52:55], 0 offen offset:1024
    s_lshl_b32 s3, s4, 8
    buffer_load_dwordx4 v[56:59], v7, s[52:55], s3 offen
    s_mov_b32 s3, 12
L_dma1:
    buffer_load_dwordx4 v8, s[48:51], s13 offen  lds
    v_xor_b32 v8, 64, v8
    s_add_u32 m0, m0, 1024
    s_add_u32 s13, s13, s42
    s_sub_u32 s3, s3, 1
    s_cmp_lg_u32 s3, 0
    s_cbranch_scc1 L_dma1
L_nojob:
    s_barrier
    s_mov_b32 s44, s40
    s_mov_b32 s45, s41
    s_mov_b32 s46, 2097152
    s_mov_b32 s47, 0x20000
    s_lshr_b32 s3, s6, 1
    s_add_u32 s3, s3, 12
    s_cmp_eq_u32 s60, 0
    s_cselect_b32 s3, s59, s3
    s_lshl_b32 s59, s3, 1
    s_add_u32 s59, s59, s4
    s_sub_u32 s59, s59, 1
    s_cmp_lt_u32 s3, 20
    s_cselect_b32 s59, s59, -1
    s_and_b32 s3, s60, 6
    s_cmp_eq_u32 s3, 2
    s_cselect_b32 s59, -1, s59
    s_sub_u32 s3, s4, 1
    s_cmp_lt_u32 s3, 2
    s_cselect_b32 s59, s59, -1
    v_lshrrev_b32 v2, 2, v0
    v_bfe_u32 v12, v2, 2, 1
    v_lshlrev_b32 v3, 7, v12
    v_lshrrev_b32 v12, 3, v2
    v_lshl_add_u32 v3, v12, 6, v3
    v_bfe_u32 v12, v2, 1, 1
    v_lshl_add_u32 v3, v12, 2, v3
    v_lshl_add_u32 v3, v4, 4, v3
    v_lshrrev_b32 v12, 1, v6
    v_lshlrev_b32 v2, 8, v12
    v_lshl_add_u32 v2, v5, 9, v2
    v_and_b32 v12, 1, v6
    v_lshl_add_u32 v2, v12, 6, v2
    v_lshl_add_u32 v2, v4, 4, v2
    s_lshl_b32 s63, s4, 11
    s_lshl_b32 s3, s4, 10
    s_add_u32 s3, s3, 512
    v_add_u32 v13, s3, v1
    s_lshl_b32 s3, s4, 8
    s_add_u32 s3, s3, 512
    v_lshlrev_b32 v14, 2, v0
    v_add_u32 v14, s3, v14
    s_cmp_gt_u32 s60, 1
    s_cbranch_scc1 L_tailw0
    v_lshlrev_b32 v9, 10, v6
    v_lshl_add_u32 v9, v5, 7, v9
    v_lshl_add_u32 v9, v4, 3, v9
    v_lshrrev_b32 v12, 1, v5
    v_lshl_add_u32 v9, v12, 5, v9
    v_and_b32 v12, 1, v6
    v_lshl_add_u32 v9, v12, 6, v9
    v_add_u32 v9, s62, v9
    s_lshl_b32 s43, s61, 2
    s_add_u32 s43, s43, s4
    s_lshl_b32 s43, s43, 8
    v_xor_b32 v16, 32, v9
    v_xor_b32 v17, 64, v9
    v_xor_b32 v18, 0x60, v9
    s_cmp_eq_u32 s60, 0
    s_cbranch_scc0 L_silu
    s_waitcnt vmcnt(12)
    s_mov_b32 s3, 0x3f803f80
    v_dot2_f32_bf16 v36, v20, s3, 0
    v_dot2_f32_bf16 v37, v20, v20, 0
    v_dot2_f32_bf16 v36, v21, s3, v36
    v_dot2_f32_bf16 v37, v21, v21, v37
    v_dot2_f32_bf16 v36, v22, s3, v36
    v_dot2_f32_bf16 v37, v22, v22, v37
    v_dot2_f32_bf16 v36, v23, s3, v36
    v_dot2_f32_bf16 v37, v23, v23, v37
    v_dot2_f32_bf16 v36, v24, s3, v36
    v_dot2_f32_bf16 v37, v24, v24, v37
    v_dot2_f32_bf16 v36, v25, s3, v36
    v_dot2_f32_bf16 v37, v25, v25, v37
    v_dot2_f32_bf16 v36, v26, s3, v36
    v_dot2_f32_bf16 v37, v26, v26, v37
    v_dot2_f32_bf16 v36, v27, s3, v36
    v_dot2_f32_bf16 v37, v27, v27, v37
    v_dot2_f32_bf16 v36, v28, s3, v36
    v_dot2_f32_bf16 v37, v28, v28, v37
    v_dot2_f32_bf16 v36, v29, s3, v36
    v_dot2_f32_bf16 v37, v29, v29, v37
    v_dot2_f32_bf16 v36, v30, s3, v36
    v_dot2_f32_bf16 v37, v30, v30, v37
    v_dot2_f32_bf16 v36, v31, s3, v36
    v_dot2_f32_bf16 v37, v31, v31, v37
    v_dot2_f32_bf16 v36, v32, s3, v36
    v_dot2_f32_bf16 v37, v32, v32, v37
    v_dot2_f32_bf16 v36, v33, s3, v36
    v_dot2_f32_bf16 v37, v33, v33, v37
    v_dot2_f32_bf16 v36, v34, s3, v36
    v_dot2_f32_bf16 v37, v34, v34, v37
    v_dot2_f32_bf16 v36, v35, s3, v36
    v_dot2_f32_bf16 v37, v35, v35, v37
    v_dot2_f32_bf16 v36, v60, s3, v36
    v_dot2_f32_bf16 v37, v60, v60, v37
    v_dot2_f32_bf16 v36, v61, s3, v36
    v_dot2_f32_bf16 v37, v61, v61, v37
    v_dot2_f32_bf16 v36, v62, s3, v36
    v_dot2_f32_bf16 v37, v62, v62, v37
    v_dot2_f32_bf16 v36, v63, s3, v36
    v_dot2_f32_bf16 v37, v63, v63, v37
    v_mov_b32 v40, v56
    v_mov_b32 v41, v57
    v_mov_b32 v42, v58
    v_mov_b32 v43, v59
    v_lshlrev_b32 v56, 16, v40
    v_and_b32 v57, 0xffff0000, v40
    v_lshlrev_b32 v58, 16, v41
    v_and_b32 v59, 0xffff0000, v41
    v_lshlrev_b32 v60, 16, v42
    v_and_b32 v61, 0xffff0000, v42
    v_lshlrev_b32 v62, 16, v43
    v_and_b32 v63, 0xffff0000, v43
    v_add_f32_dpp v36, v36, v36 row_ror:4 row_mask:0xf bank_mask:0xf
    v_add_f32_dpp v37, v37, v37 row_ror:4 row_mask:0xf bank_mask:0xf
    s_nop 0
    v_add_f32_dpp v36, v36, v36 row_ror:8 row_mask:0xf bank_mask:0xf
    v_add_f32_dpp v37, v37, v37 row_ror:8 row_mask:0xf bank_mask:0xf
    s_nop 1
    v_permlane16_swap_b32 v36, v37
    v_add_f32 v36, v36, v37
    v_mov_b32 v38, v36
    s_nop 1
    v_permlane32_swap_b32 v36, v38
    v_add_f32 v36, v36, v38
    v_mov_b32 v37, v36
    s_nop 1
    v_permlane16_swap_b32 v36, v37
    v_mul_f32 v36, 0x3acccccd, v36
    v_mul_f32 v37, 0x3acccccd, v37
    v_fma_f32 v37, -v36, v36, v37
    v_max_f32 v37, 0, v37
    v_cvt_pk_bf16_f32 v38, v36, v37
    v_and_b32 v37, 0xffff0000, v38
    v_lshlrev_b32 v36, 16, v38
    v_add_f32 v37, 0x3727c5ac, v37
    v_cvt_pk_bf16_f32 v37, v37, v37
    v_lshlrev_b32 v37, 16, v37
    v_sqrt_f32 v37, v37
    s_nop 0
    v_cvt_pk_bf16_f32 v37, v37, v37
    v_lshlrev_b32 v37, 16, v37
    v_rcp_f32 v37, v37
    s_nop 0
    v_pk_add_f32 v[56:57], v[56:57], v[36:37] op_sel_hi:[1,0] neg_lo:[0,1] neg_hi:[0,1]
    v_pk_add_f32 v[58:59], v[58:59], v[36:37] op_sel_hi:[1,0] neg_lo:[0,1] neg_hi:[0,1]
    v_pk_add_f32 v[60:61], v[60:61], v[36:37] op_sel_hi:[1,0] neg_lo:[0,1] neg_hi:[0,1]
    v_pk_add_f32 v[62:63], v[62:63], v[36:37] op_sel_hi:[1,0] neg_lo:[0,1] neg_hi:[0,1]
    v_cvt_pk_bf16_f32 v40, v56, v57
    v_cvt_pk_bf16_f32 v41, v58, v59
    v_cvt_pk_bf16_f32 v42, v60, v61
    v_cvt_pk_bf16_f32 v43, v62, v63
    v_lshlrev_b32 v56, 16, v40
    v_and_b32 v57, 0xffff0000, v40
    v_lshlrev_b32 v58, 16, v41
    v_and_b32 v59, 0xffff0000, v41
    v_lshlrev_b32 v60, 16, v42
    v_and_b32 v61, 0xffff0000, v42
    v_lshlrev_b32 v62, 16, v43
    v_and_b32 v63, 0xffff0000, v43
    v_pk_mul_f32 v[56:57], v[56:57], v[36:37] op_sel:[0,1] op_sel_hi:[1,1]
    v_pk_mul_f32 v[58:59], v[58:59], v[36:37] op_sel:[0,1] op_sel_hi:[1,1]
    v_pk_mul_f32 v[60:61], v[60:61], v[36:37] op_sel:[0,1] op_sel_hi:[1,1]
    v_pk_mul_f32 v[62:63], v[62:63], v[36:37] op_sel:[0,1] op_sel_hi:[1,1]
    v_cvt_pk_bf16_f32 v40, v56, v57
    v_cvt_pk_bf16_f32 v41, v58, v59
    v_cvt_pk_bf16_f32 v42, v60, v61
    v_cvt_pk_bf16_f32 v43, v62, v63
    v_lshlrev_b32 v56, 16, v40
    v_and_b32 v57, 0xffff0000, v40
    v_lshlrev_b32 v58, 16, v41
    v_and_b32 v59, 0xffff0000, v41
    v_lshlrev_b32 v60, 16, v42
    v_and_b32 v61, 0xffff0000, v42
    v_lshlrev_b32 v62, 16, v43
    v_and_b32 v63, 0xffff0000, v43
    v_lshlrev_b32 v15, 6, v4
    v_lshrrev_b32 v12, 3, v0
    v_lshl_add_u32 v15, v12, 3, v15
    s_add_u32 s43, s43, 106496
    s_branch L_btr
L_silu:
    s_waitcnt vmcnt(22)
    v_lshlrev_b32 v48, 16, v36
    v_and_b32 v49, 0xffff0000, v36
    v_lshlrev_b32 v50, 16, v37
    v_and_b32 v51, 0xffff0000, v37
    v_lshlrev_b32 v52, 16, v38
    v_and_b32 v53, 0xffff0000, v38
    v_lshlrev_b32 v54, 16, v39
    v_and_b32 v55, 0xffff0000, v39
    v_mul_f32 v36, 0xbfb8aa3b, v48
    v_mul_f32 v37, 0xbfb8aa3b, v49
    v_mul_f32 v38, 0xbfb8aa3b, v50
    v_mul_f32 v39, 0xbfb8aa3b, v51
    v_mul_f32 v40, 0xbfb8aa3b, v52
    v_mul_f32 v41, 0xbfb8aa3b, v53
    v_mul_f32 v42, 0xbfb8aa3b, v54
    v_mul_f32 v43, 0xbfb8aa3b, v55
    v_exp_f32 v36, v36
    v_exp_f32 v37, v37
    v_exp_f32 v38, v38
    v_exp_f32 v39, v39
    v_exp_f32 v40, v40
    v_exp_f32 v41, v41
    v_exp_f32 v42, v42
    v_exp_f32 v43, v43
    v_pk_add_f32 v[36:37], v[36:37], 1.0 op_sel_hi:[1,0]
    v_pk_add_f32 v[38:39], v[38:39], 1.0 op_sel_hi:[1,0]
    v_pk_add_f32 v[40:41], v[40:41], 1.0 op_sel_hi:[1,0]
    v_pk_add_f32 v[42:43], v[42:43], 1.0 op_sel_hi:[1,0]
    v_rcp_f32 v36, v36
    v_rcp_f32 v37, v37
    v_rcp_f32 v38, v38
    v_rcp_f32 v39, v39
    v_rcp_f32 v40, v40
    v_rcp_f32 v41, v41
    v_rcp_f32 v42, v42
    v_rcp_f32 v43, v43
    v_pk_mul_f32 v[48:49], v[48:49], v[36:37]
    v_pk_mul_f32 v[50:51], v[50:51], v[38:39]
    v_pk_mul_f32 v[52:53], v[52:53], v[40:41]
    v_pk_mul_f32 v[54:55], v[54:55], v[42:43]
    v_cvt_pk_bf16_f32 v40, v48, v49
    v_cvt_pk_bf16_f32 v41, v50, v51
    v_cvt_pk_bf16_f32 v42, v52, v53
    v_cvt_pk_bf16_f32 v43, v54, v55
    v_mov_b32_dpp v44, v40 row_shl:4 row_mask:0xf bank_mask:0xf bound_ctrl:0
    v_mov_b32_dpp v45, v41 row_shl:4 row_mask:0xf bank_mask:0xf bound_ctrl:0
    v_mov_b32_dpp v46, v42 row_shl:4 row_mask:0xf bank_mask:0xf bound_ctrl:0
    v_mov_b32_dpp v47, v43 row_shl:4 row_mask:0xf bank_mask:0xf bound_ctrl:0
    v_mov_b32_dpp v48, v40 row_shl:8 row_mask:0xf bank_mask:0xf bound_ctrl:0
    v_mov_b32_dpp v49, v41 row_shl:8 row_mask:0xf bank_mask:0xf bound_ctrl:0
    v_mov_b32_dpp v50, v42 row_shl:8 row_mask:0xf bank_mask:0xf bound_ctrl:0
    v_mov_b32_dpp v51, v43 row_shl:8 row_mask:0xf bank_mask:0xf bound_ctrl:0
    v_mov_b32_dpp v52, v40 row_shl:12 row_mask:0xf bank_mask:0xf bound_ctrl:0
    v_mov_b32_dpp v53, v41 row_shl:12 row_mask:0xf bank_mask:0xf bound_ctrl:0
    v_mov_b32_dpp v54, v42 row_shl:12 row_mask:0xf bank_mask:0xf bound_ctrl:0
    v_mov_b32_dpp v55, v43 row_shl:12 row_mask:0xf bank_mask:0xf bound_ctrl:0
    s_add_u32 s43, s43, 45056
L_btr:
    s_waitcnt lgkmcnt(0)
    s_mul_i32 s9, s9, 0x9e3779b1
    s_add_u32 s9, s9, 0x7f4a7c15
    s_waitcnt vmcnt(12)
    ds_read_b64_tr_b16 v[64:65], v9 offset:0
    ds_read_b64_tr_b16 v[66:67], v9 offset:512
    ds_read_b64_tr_b16 v[80:81], v16 offset:0
    ds_read_b64_tr_b16 v[82:83], v16 offset:512
    ds_read_b64_tr_b16 v[96:97], v17 offset:0
    ds_read_b64_tr_b16 v[98:99], v17 offset:512
    ds_read_b64_tr_b16 v[112:113], v18 offset:0
    ds_read_b64_tr_b16 v[114:115], v18 offset:512
    s_waitcnt vmcnt(8)
    ds_read_b64_tr_b16 v[68:69], v9 offset:4096
    ds_read_b64_tr_b16 v[70:71], v9 offset:4608
    ds_read_b64_tr_b16 v[84:85], v16 offset:4096
    ds_read_b64_tr_b16 v[86:87], v16 offset:4608
    ds_read_b64_tr_b16 v[100:101], v17 offset:4096
    ds_read_b64_tr_b16 v[102:103], v17 offset:4608
    ds_read_b64_tr_b16 v[116:117], v18 offset:4096
    ds_read_b64_tr_b16 v[118:119], v18 offset:4608
    s_waitcnt vmcnt(4)
    ds_read_b64_tr_b16 v[72:73], v9 offset:8192
    ds_read_b64_tr_b16 v[74:75], v9 offset:8704
    ds_read_b64_tr_b16 v[88:89], v16 offset:8192
    ds_read_b64_tr_b16 v[90:91], v16 offset:8704
    ds_read_b64_tr_b16 v[104:105], v17 offset:8192
    ds_read_b64_tr_b16 v[106:107], v17 offset:8704
    ds_read_b64_tr_b16 v[120:121], v18 offset:8192
    ds_read_b64_tr_b16 v[122:123], v18 offset:8704
    s_waitcnt vmcnt(0)
    ds_read_b64_tr_b16 v[76:77], v9 offset:12288
    ds_read_b64_tr_b16 v[78:79], v9 offset:12800
    ds_read_b64_tr_b16 v[92:93], v16 offset:12288
    ds_read_b64_tr_b16 v[94:95], v16 offset:12800
    ds_read_b64_tr_b16 v[108:109], v17 offset:12288
    ds_read_b64_tr_b16 v[110:111], v17 offset:12800
    ds_read_b64_tr_b16 v[124:125], v18 offset:12288
    ds_read_b64_tr_b16 v[126:127], v18 offset:12800
    s_cmp_eq_u32 s60, 0
    s_cbranch_scc0 L_amov
    s_add_u32 s3, s63, 45056
    s_add_u32 s13, s63, 55296
L_hpoll:
    buffer_load_dwordx4 v[28:31], v2, s[44:47], s13 offen sc1
    buffer_load_dwordx4 v[32:35], v2, s[44:47], s13 offen offset:128 sc1
    buffer_load_dwordx4 v[20:23], v2, s[44:47], s3 offen sc1
    buffer_load_dwordx4 v[24:27], v2, s[44:47], s3 offen offset:128 sc1
    s_waitcnt vmcnt(0)
    v_xor_b32 v36, s9, v22
    v_bitop3_b32 v36, v36, v26, s9 bitop3:0xf6
    v_bitop3_b32 v36, v36, v30, s9 bitop3:0xf6
    v_bitop3_b32 v36, v36, v34, s9 bitop3:0xf6
    v_cmp_ne_u32 vcc, 0, v36
    s_cbranch_vccz L_hpoll_ok
    s_sleep 1
    s_sub_u32 s95, s95, 1
    s_cbranch_scc0 L_hpoll
    s_mov_b32 s95, 0
L_hpoll_ok:
    v_lshlrev_b32 v44, 16, v28
    v_and_b32 v45, 0xffff0000, v28
    v_lshlrev_b32 v46, 16, v29
    v_and_b32 v47, 0xffff0000, v29
    v_lshlrev_b32 v48, 16, v32
    v_and_b32 v49, 0xffff0000, v32
    v_lshlrev_b32 v50, 16, v33
    v_and_b32 v51, 0xffff0000, v33
    v_pk_add_f32 v[44:45], v[44:45], 1.0 op_sel_hi:[1,0]
    v_pk_add_f32 v[46:47], v[46:47], 1.0 op_sel_hi:[1,0]
    v_pk_add_f32 v[48:49], v[48:49], 1.0 op_sel_hi:[1,0]
    v_pk_add_f32 v[50:51], v[50:51], 1.0 op_sel_hi:[1,0]
    v_cvt_pk_bf16_f32 v36, v44, v45
    v_cvt_pk_bf16_f32 v37, v46, v47
    v_cvt_pk_bf16_f32 v38, v48, v49
    v_cvt_pk_bf16_f32 v39, v50, v51
    v_lshlrev_b32 v44, 16, v36
    v_and_b32 v45, 0xffff0000, v36
    v_lshlrev_b32 v46, 16, v37
    v_and_b32 v47, 0xffff0000, v37
    v_lshlrev_b32 v48, 16, v38
    v_and_b32 v49, 0xffff0000, v38
    v_lshlrev_b32 v50, 16, v39
    v_and_b32 v51, 0xffff0000, v39
    v_pk_mul_f32 v[44:45], v[44:45], v[56:57]
    v_pk_mul_f32 v[46:47], v[46:47], v[58:59]
    v_pk_mul_f32 v[48:49], v[48:49], v[60:61]
    v_pk_mul_f32 v[50:51], v[50:51], v[62:63]
    v_lshlrev_b32 v56, 16, v20
    v_and_b32 v57, 0xffff0000, v20
    v_lshlrev_b32 v58, 16, v21
    v_and_b32 v59, 0xffff0000, v21
    v_lshlrev_b32 v60, 16, v24
    v_and_b32 v61, 0xffff0000, v24
    v_lshlrev_b32 v62, 16, v25
    v_and_b32 v63, 0xffff0000, v25
    v_cvt_pk_bf16_f32 v36, v44, v45
    v_cvt_pk_bf16_f32 v37, v46, v47
    v_cvt_pk_bf16_f32 v38, v48, v49
    v_cvt_pk_bf16_f32 v39, v50, v51
    v_lshlrev_b32 v44, 16, v36
    v_and_b32 v45, 0xffff0000, v36
    v_lshlrev_b32 v46, 16, v37
    v_and_b32 v47, 0xffff0000, v37
    v_lshlrev_b32 v48, 16, v38
    v_and_b32 v49, 0xffff0000, v38
    v_lshlrev_b32 v50, 16, v39
    v_and_b32 v51, 0xffff0000, v39
    v_pk_add_f32 v[44:45], v[44:45], v[56:57]
    v_pk_add_f32 v[46:47], v[46:47], v[58:59]
    v_pk_add_f32 v[48:49], v[48:49], v[60:61]
    v_pk_add_f32 v[50:51], v[50:51], v[62:63]
    v_cvt_pk_bf16_f32 v40, v44, v45
    v_cvt_pk_bf16_f32 v41, v46, v47
    v_cvt_pk_bf16_f32 v42, v48, v49
    v_cvt_pk_bf16_f32 v43, v50, v51
    v_mov_b32_dpp v44, v40 row_shl:4 row_mask:0xf bank_mask:0xf bound_ctrl:0
    v_mov_b32_dpp v45, v41 row_shl:4 row_mask:0xf bank_mask:0xf bound_ctrl:0
    v_mov_b32_dpp v46, v42 row_shl:4 row_mask:0xf bank_mask:0xf bound_ctrl:0
    v_mov_b32_dpp v47, v43 row_shl:4 row_mask:0xf bank_mask:0xf bound_ctrl:0
    v_mov_b32_dpp v48, v40 row_shl:8 row_mask:0xf bank_mask:0xf bound_ctrl:0
    v_mov_b32_dpp v49, v41 row_shl:8 row_mask:0xf bank_mask:0xf bound_ctrl:0
    v_mov_b32_dpp v50, v42 row_shl:8 row_mask:0xf bank_mask:0xf bound_ctrl:0
    v_mov_b32_dpp v51, v43 row_shl:8 row_mask:0xf bank_mask:0xf bound_ctrl:0
    v_mov_b32_dpp v52, v40 row_shl:12 row_mask:0xf bank_mask:0xf bound_ctrl:0
    v_mov_b32_dpp v53, v41 row_shl:12 row_mask:0xf bank_mask:0xf bound_ctrl:0
    v_mov_b32_dpp v54, v42 row_shl:12 row_mask:0xf bank_mask:0xf bound_ctrl:0
    v_mov_b32_dpp v55, v43 row_shl:12 row_mask:0xf bank_mask:0xf bound_ctrl:0
L_amov:
    s_waitcnt lgkmcnt(8)
    v_mfma_f32_16x16x32_bf16 v[20:23], v[40:43], v[64:67], 0
    v_mfma_f32_16x16x32_bf16 v[24:27], v[40:43], v[80:83], 0
    v_mfma_f32_16x16x32_bf16 v[28:31], v[40:43], v[96:99], 0
    v_mfma_f32_16x16x32_bf16 v[32:35], v[40:43], v[112:115], 0
    v_mfma_f32_16x16x32_bf16 v[20:23], v[44:47], v[68:71], v[20:23]
    v_mfma_f32_16x16x32_bf16 v[24:27], v[44:47], v[84:87], v[24:27]
    v_mfma_f32_16x16x32_bf16 v[28:31], v[44:47], v[100:103], v[28:31]
    v_mfma_f32_16x16x32_bf16 v[32:35], v[44:47], v[116:119], v[32:35]
    v_mfma_f32_16x16x32_bf16 v[20:23], v[48:51], v[72:75], v[20:23]
    v_mfma_f32_16x16x32_bf16 v[24:27], v[48:51], v[88:91], v[24:27]
    v_mfma_f32_16x16x32_bf16 v[28:31], v[48:51], v[104:107], v[28:31]
    v_mfma_f32_16x16x32_bf16 v[32:35], v[48:51], v[120:123], v[32:35]
    s_waitcnt lgkmcnt(0)
    v_mfma_f32_16x16x32_bf16 v[20:23], v[52:55], v[76:79], v[20:23]
    v_mfma_f32_16x16x32_bf16 v[24:27], v[52:55], v[92:95], v[24:27]
    v_mfma_f32_16x16x32_bf16 v[28:31], v[52:55], v[108:111], v[28:31]
    v_mfma_f32_16x16x32_bf16 v[32:35], v[52:55], v[124:127], v[32:35]
    s_mov_b64 exec, 0xffff
    s_nop 3
    ds_write_b128 v13, v[20:23] offset:0
    ds_write_b128 v13, v[24:27] offset:256
    ds_write_b128 v13, v[28:31] offset:512
    ds_write_b128 v13, v[32:35] offset:768
    s_mov_b64 exec, 1
    ds_add_u32 v10, v11 offset:0
    s_mov_b64 exec, -1
    s_cmp_eq_u32 s4, 4
    s_cbranch_scc0 L_fin0
L_w1:
    ds_read_b32 v12, v10 offset:4
    s_waitcnt lgkmcnt(0)
    v_readfirstlane_b32 s3, v12
    s_cmp_ge_u32 s3, 4
    s_cbranch_scc1 L_w1_x
    s_sub_u32 s95, s95, 1
    s_cbranch_scc0 L_w1
    s_mov_b32 s95, 0
L_w1_x:
    s_branch L_tailw
L_fin0:
    v_mov_b32 v50, s9
    v_mov_b32 v51, s9
    v_mov_b32 v41, s9
L_w0:
    ds_read_b32 v12, v10 offset:0
    s_waitcnt lgkmcnt(0)
    v_readfirstlane_b32 s3, v12
    s_cmp_ge_u32 s3, 5
    s_cbranch_scc1 L_w0_x
    s_sub_u32 s95, s95, 1
    s_cbranch_scc0 L_w0
    s_mov_b32 s95, 0
L_w0_x:
    ds_read2st64_b32 v[42:43], v14 offset0:0 offset1:4
    ds_read2st64_b32 v[44:45], v14 offset0:8 offset1:12
    ds_read_b32 v46, v14 offset:4096
    s_waitcnt lgkmcnt(0)
    v_add_f32 v42, v42, v43
    v_add_f32 v44, v44, v45
    v_add_f32 v42, v42, v46
    v_add_f32 v42, v42, v44
    s_cmp_eq_u32 s60, 0
    s_cbranch_scc1 L_finq
    v_mov_b32_dpp v49, v42 row_shl:4 row_mask:0xf bank_mask:0xf bound_ctrl:0
    v_cvt_pk_bf16_f32 v48, v42, v49
    s_nop 1
    v_mov_b32_dpp v49, v48 row_shl:8 row_mask:0xf bank_mask:0xf bound_ctrl:0
    s_mov_b32 exec_lo, 0x000f000f
    s_mov_b32 exec_hi, 0x000f000f
    buffer_store_dwordx4 v[48:51], v3, s[44:47], s43 offen sc1
    s_branch L_fin1
L_finq:
    v_mov_b32_dpp v43, v42 row_shl:4 row_mask:0xf bank_mask:0xf bound_ctrl:0
    v_cvt_pk_bf16_f32 v40, v42, v43
    s_mov_b32 exec_lo, 0x0f0f0f0f
    s_mov_b32 exec_hi, 0x0f0f0f0f
    buffer_store_dwordx2 v[40:41], v15, s[44:47], s43 offen sc1
L_fin1:
    s_mov_b64 exec, 1
    ds_add_u32 v10, v11 offset:4
    s_mov_b64 exec, -1
    s_branch L_tailw
L_tailw0:
    s_waitcnt lgkmcnt(0)
    s_mul_i32 s9, s9, 0x9e3779b1
    s_add_u32 s9, s9, 0x7f4a7c15
    s_cmp_eq_u32 s60, 2
    s_cbranch_scc0 L_twF2
    v_lshrrev_b32 v8, 2, v0
    s_lshl_b32 s3, s4, 7
    v_add_u32 v8, s3, v8
    v_mul_u32_u24 v8, 3072, v8
    v_lshl_add_u32 v8, v4, 4, v8
    s_mov_b32 s48, s28
    s_mov_b32 s49, s29
    s_mov_b32 s50, 1966080
    s_mov_b32 s51, 0x20000
    s_lshl_b32 s13, s61, 6
    s_mov_b32 m0, s62
    s_mov_b32 s3, 8
L_dma5:
    buffer_load_dwordx4 v8, s[48:51], s13 offen  lds
    s_add_u32 m0, m0, 1024
    s_add_u32 s13, s13, 49152
    s_sub_u32 s3, s3, 1
    s_cmp_lg_u32 s3, 0
    s_cbranch_scc1 L_dma5
    s_mov_b32 s48, s30
    s_mov_b32 s49, s31
    s_mov_b32 s50, 1966080
    s_mov_b32 s51, 0x20000
    s_lshl_b32 s13, s61, 6
    s_mov_b32 s3, 8
L_dma6:
    buffer_load_dwordx4 v8, s[48:51], s13 offen  lds
    s_add_u32 m0, m0, 1024
    s_add_u32 s13, s13, 49152
    s_sub_u32 s3, s3, 1
    s_cmp_lg_u32 s3, 0
    s_cbranch_scc1 L_dma6
    s_branch L_tailw
L_twF2:
    s_cmp_eq_u32 s60, 3
    s_cbranch_scc0 L_tailw
    s_cmp_eq_u32 s4, 4
    s_cbranch_scc1 L_tailw
    v_lshrrev_b32 v8, 1, v0
    v_mul_u32_u24 v8, 1280, v8
    v_and_b32 v12, 1, v0
    v_lshl_add_u32 v8, v12, 4, v8
    s_mov_b32 s48, s32
    s_mov_b32 s49, s33
    s_mov_b32 s50, 1966080
    s_mov_b32 s51, 0x20000
    s_mul_i32 s13, s4, 491520
    s_lshl_b32 s3, s61, 5
    s_add_u32 s13, s13, s3
    s_mov_b32 m0, s62
    s_mov_b32 s3, 12
L_dma4:
    buffer_load_dwordx4 v8, s[48:51], s13 offen  lds
    s_add_u32 m0, m0, 1024
    s_add_u32 s13, s13, 40960
    s_sub_u32 s3, s3, 1
    s_cmp_lg_u32 s3, 0
    s_cbranch_scc1 L_dma4
L_tailw:
    s_setprio 0
    s_cmp_eq_u32 s4, 0
    s_cbranch_scc0 L_xp
    s_getreg_b32 s3, hwreg(HW_REG_XCC_ID)
    v_mov_b32 v24, s3
    v_mov_b32 v25, s9
    s_lshl_b32 s3, s5, 5
    s_add_u32 s3, s3, s6
    s_lshl_b32 s3, s3, 7
    s_add_u32 s3, s3, 1114112
    s_mov_b64 exec, 1
    buffer_store_dwordx2 v[24:25], v10, s[44:47], s3 offen sc1
    s_mov_b64 exec, -1
L_xp:
    s_mov_b32 s48, s24
    s_mov_b32 s49, s25
    s_mov_b32 s50, 7864320
    s_mov_b32 s51, 0x20000
    s_mul_i32 s13, s7, 245760
    s_mul_i32 s3, s8, 160
    s_add_u32 s13, s13, s3
    s_mul_i32 s3, s4, 6144
    s_add_u32 m0, s3, 19072
    s_mul_i32 s3, s4, 384
    v_add_u32 v9, s3, v0
    v_mul_u32_u24 v8, 6554, v9
    v_lshrrev_b32 v8, 16, v8
    v_mul_u32_u24 v8, 1120, v8
    v_lshl_add_u32 v8, v9, 4, v8
    s_mov_b32 s3, 6
L_dma3:
    buffer_load_dwordx4 v8, s[48:51], s13 offen  lds
    v_add_u32 v9, 64, v9
    v_mul_u32_u24 v8, 6554, v9
    v_lshrrev_b32 v8, 16, v8
    v_mul_u32_u24 v8, 1120, v8
    v_lshl_add_u32 v8, v9, 4, v8
    s_add_u32 m0, m0, 1024
    s_sub_u32 s3, s3, 1
    s_cmp_lg_u32 s3, 0
    s_cbranch_scc1 L_dma3
    s_mov_b32 s58, 0x3fb8aa3b
    s_mov_b32 s56, 0
    s_mov_b32 s57, -1
    s_mov_b32 s12, 0
    s_mov_b32 s52, s38
    s_mov_b32 s53, s39
    s_mov_b32 s54, 5120
    s_mov_b32 s55, 0x20000
    s_mul_i32 s14, s7, 5120
    s_add_u32 s14, s14, 204800
    s_mul_i32 s15, s8, 640
    s_add_u32 s15, s15, s14
    s_lshl_b32 s3, s4, 10
    s_add_u32 s14, s14, s3
    s_lshl_b32 s3, s4, 6
    v_add_u32 v12, s3, v0
    v_mul_u32_u24 v15, 1639, v12
    v_lshrrev_b32 v15, 16, v15
    v_mul_u32_u24 v16, 40, v15
    v_sub_u32 v16, v12, v16
    v_cmp_gt_u32 s[96:97], 33, v16
    v_add_u32 v15, v15, v12
    v_lshlrev_b32 v15, 4, v15
    v_add_u32 v15, 5632, v15
    v_and_b32 v12, 7, v0
    v_mul_u32_u24 v16, 656, v12
    v_lshl_add_u32 v16, v6, 4, v16
    v_add_u32 v16, 5632, v16
    v_and_b32 v17, 1, v6
    v_lshl_add_u32 v17, v17, 2, v4
    v_mul_u32_u24 v17, 656, v17
    v_add_u32 v17, 6144, v17
    v_lshrrev_b32 v19, 5, v0
    v_lshlrev_b32 v18, 2, v19
    v_xor_b32 v12, v12, v18
    v_lshlrev_b32 v18, 10, v12
    v_add_u32 v18, 10880, v18
    v_and_b32 v12, 31, v0
    v_lshlrev_b32 v12, 4, v12
    v_lshl_add_u32 v19, v19, 12, v12
    v_add_u32 v19, 10880, v19
    v_mul_u32_u24 v12, 960, v6
    v_lshl_add_u32 v12, v4, 3, v12
    s_lshl_b32 s3, s4, 5
    s_add_u32 s3, s3, 19072
    v_add_u32 v12, s3, v12
    v_mul_u32_u24 v7, 160, v5
    v_add_u32 v7, v7, v12
    v_and_b32 v8, 1, v5
    v_mul_u32_u24 v8, 160, v8
    v_add_u32 v8, v8, v12
    v_add_u32 v8, 640, v8
    s_mul_i32 s43, s8, 5
    s_add_u32 s43, s43, s4
    s_lshl_b32 s43, s43, 5
    s_add_u32 s43, s43, s7
    s_lshl_b32 s43, s43, 8
    s_add_u32 s43, s43, 368640
    s_cmp_eq_u32 s60, 2
    s_cselect_b32 s3, 6, 5
    s_add_u32 s13, s3, 3
    v_lshlrev_b32 v9, s13, v6
    v_lshlrev_b32 v20, s3, v5
    v_add_u32 v9, v9, v20
    v_lshl_add_u32 v9, v4, 3, v9
    v_add_u32 v9, s62, v9
    s_waitcnt vmcnt(0)
    s_mov_b64 exec, 1
    ds_add_u32 v10, v11 offset:8
    s_mov_b64 exec, -1
L_xg:
    ds_read_b32 v12, v10 offset:28
    s_waitcnt lgkmcnt(0)
    v_readfirstlane_b32 s3, v12
    s_cmp_ge_u32 s3, 1
    s_cbranch_scc1 L_xg_x
    s_sleep 64
    s_sub_u32 s95, s95, 1
    s_cbranch_scc0 L_xg
    s_mov_b32 s95, 0
L_xg_x:
    s_cmp_eq_u32 s60, 2
    s_cbranch_scc0 L_preW
    s_add_u32 s3, s63, 75776
    s_add_u32 s13, s63, 86016
L_scpoll:
    buffer_load_dwordx4 v[36:39], v2, s[44:47], s13 offen sc1
    buffer_load_dwordx4 v[40:43], v2, s[44:47], s13 offen offset:128 sc1
    buffer_load_dwordx4 v[44:47], v2, s[44:47], s3 offen sc1
    buffer_load_dwordx4 v[48:51], v2, s[44:47], s3 offen offset:128 sc1
    s_waitcnt vmcnt(0)
    v_xor_b32 v52, s9, v38
    v_bitop3_b32 v52, v52, v42, s9 bitop3:0xf6
    v_bitop3_b32 v52, v52, v46, s9 bitop3:0xf6
    v_bitop3_b32 v52, v52, v50, s9 bitop3:0xf6
    v_cmp_ne_u32 vcc, 0, v52
    s_cbranch_vccz L_scpoll_ok
    s_sleep 8
    s_sub_u32 s95, s95, 1
    s_cbranch_scc0 L_scpoll
    s_mov_b32 s95, 0
L_scpoll_ok:
    ds_read_b64_tr_b16 v[64:65], v9 offset:0
    ds_read_b64_tr_b16 v[66:67], v9 offset:256
    ds_read_b64_tr_b16 v[68:69], v9 offset:2048
    ds_read_b64_tr_b16 v[70:71], v9 offset:2304
    ds_read_b64_tr_b16 v[72:73], v9 offset:4096
    ds_read_b64_tr_b16 v[74:75], v9 offset:4352
    ds_read_b64_tr_b16 v[76:77], v9 offset:6144
    ds_read_b64_tr_b16 v[78:79], v9 offset:6400
    ds_read_b64_tr_b16 v[80:81], v9 offset:32
    ds_read_b64_tr_b16 v[82:83], v9 offset:288
    ds_read_b64_tr_b16 v[84:85], v9 offset:2080
    ds_read_b64_tr_b16 v[86:87], v9 offset:2336
    ds_read_b64_tr_b16 v[88:89], v9 offset:4128
    ds_read_b64_tr_b16 v[90:91], v9 offset:4384
    ds_read_b64_tr_b16 v[92:93], v9 offset:6176
    ds_read_b64_tr_b16 v[94:95], v9 offset:6432
    ds_read_b64_tr_b16 v[96:97], v9 offset:8192
    ds_read_b64_tr_b16 v[98:99], v9 offset:8448
    ds_read_b64_tr_b16 v[100:101], v9 offset:10240
    ds_read_b64_tr_b16 v[102:103], v9 offset:10496
    ds_read_b64_tr_b16 v[104:105], v9 offset:12288
    ds_read_b64_tr_b16 v[106:107], v9 offset:12544
    ds_read_b64_tr_b16 v[108:109], v9 offset:14336
    ds_read_b64_tr_b16 v[110:111], v9 offset:14592
    ds_read_b64_tr_b16 v[112:113], v9 offset:8224
    ds_read_b64_tr_b16 v[114:115], v9 offset:8480
    ds_read_b64_tr_b16 v[116:117], v9 offset:10272
    ds_read_b64_tr_b16 v[118:119], v9 offset:10528
    ds_read_b64_tr_b16 v[120:121], v9 offset:12320
    ds_read_b64_tr_b16 v[122:123], v9 offset:12576
    ds_read_b64_tr_b16 v[124:125], v9 offset:14368
    ds_read_b64_tr_b16 v[126:127], v9 offset:14624
    v_lshlrev_b32 v20, 16, v36
    v_and_b32 v21, 0xffff0000, v36
    v_lshlrev_b32 v22, 16, v37
    v_and_b32 v23, 0xffff0000, v37
    v_lshlrev_b32 v24, 16, v40
    v_and_b32 v25, 0xffff0000, v40
    v_lshlrev_b32 v26, 16, v41
    v_and_b32 v27, 0xffff0000, v41
    v_pk_add_f32 v[20:21], v[20:21], 1.0 op_sel_hi:[1,0]
    v_pk_add_f32 v[22:23], v[22:23], 1.0 op_sel_hi:[1,0]
    v_pk_add_f32 v[24:25], v[24:25], 1.0 op_sel_hi:[1,0]
    v_pk_add_f32 v[26:27], v[26:27], 1.0 op_sel_hi:[1,0]
    v_mov_b32 v60, v44
    v_mov_b32 v61, v45
    v_mov_b32 v62, v48
    v_mov_b32 v63, v49
    v_cvt_pk_bf16_f32 v40, v20, v21
    v_cvt_pk_bf16_f32 v41, v22, v23
    v_cvt_pk_bf16_f32 v42, v24, v25
    v_cvt_pk_bf16_f32 v43, v26, v27
    v_lshlrev_b32 v20, 16, v40
    v_and_b32 v21, 0xffff0000, v40
    v_lshlrev_b32 v22, 16, v41
    v_and_b32 v23, 0xffff0000, v41
    v_lshlrev_b32 v24, 16, v42
    v_and_b32 v25, 0xffff0000, v42
    v_lshlrev_b32 v26, 16, v43
    v_and_b32 v27, 0xffff0000, v43
    v_mov_b32_dpp v44, v40 row_shl:4 row_mask:0xf bank_mask:0xf bound_ctrl:0
    v_mov_b32_dpp v45, v41 row_shl:4 row_mask:0xf bank_mask:0xf bound_ctrl:0
    v_mov_b32_dpp v46, v42 row_shl:4 row_mask:0xf bank_mask:0xf bound_ctrl:0
    v_mov_b32_dpp v47, v43 row_shl:4 row_mask:0xf bank_mask:0xf bound_ctrl:0
    v_mov_b32_dpp v48, v40 row_shl:8 row_mask:0xf bank_mask:0xf bound_ctrl:0
    v_mov_b32_dpp v49, v41 row_shl:8 row_mask:0xf bank_mask:0xf bound_ctrl:0
    v_mov_b32_dpp v50, v42 row_shl:8 row_mask:0xf bank_mask:0xf bound_ctrl:0
    v_mov_b32_dpp v51, v43 row_shl:8 row_mask:0xf bank_mask:0xf bound_ctrl:0
    v_mov_b32_dpp v52, v40 row_shl:12 row_mask:0xf bank_mask:0xf bound_ctrl:0
    v_mov_b32_dpp v53, v41 row_shl:12 row_mask:0xf bank_mask:0xf bound_ctrl:0
    v_mov_b32_dpp v54, v42 row_shl:12 row_mask:0xf bank_mask:0xf bound_ctrl:0
    v_mov_b32_dpp v55, v43 row_shl:12 row_mask:0xf bank_mask:0xf bound_ctrl:0
    s_waitcnt lgkmcnt(0)
    v_mfma_f32_16x16x32_bf16 v[32:35], v[40:43], v[64:67], 0
    v_mfma_f32_16x16x32_bf16 v[36:39], v[40:43], v[80:83], 0
    v_mfma_f32_16x16x32_bf16 v[56:59], v[40:43], v[96:99], 0
    v_mfma_f32_16x16x32_bf16 v[28:31], v[40:43], v[112:115], 0
    v_mfma_f32_16x16x32_bf16 v[32:35], v[44:47], v[68:71], v[32:35]
    v_mfma_f32_16x16x32_bf16 v[36:39], v[44:47], v[84:87], v[36:39]
    v_mfma_f32_16x16x32_bf16 v[56:59], v[44:47], v[100:103], v[56:59]
    v_mfma_f32_16x16x32_bf16 v[28:31], v[44:47], v[116:119], v[28:31]
    v_mfma_f32_16x16x32_bf16 v[32:35], v[48:51], v[72:75], v[32:35]
    v_mfma_f32_16x16x32_bf16 v[36:39], v[48:51], v[88:91], v[36:39]
    v_mfma_f32_16x16x32_bf16 v[56:59], v[48:51], v[104:107], v[56:59]
    v_mfma_f32_16x16x32_bf16 v[28:31], v[48:51], v[120:123], v[28:31]
    v_mfma_f32_16x16x32_bf16 v[32:35], v[52:55], v[76:79], v[32:35]
    v_mfma_f32_16x16x32_bf16 v[36:39], v[52:55], v[92:95], v[36:39]
    v_mfma_f32_16x16x32_bf16 v[56:59], v[52:55], v[108:111], v[56:59]
    v_mfma_f32_16x16x32_bf16 v[28:31], v[52:55], v[124:127], v[28:31]
    s_mov_b64 exec, 0xffff
    s_nop 3
    ds_write_b128 v13, v[32:35] offset:0
    ds_write_b128 v13, v[36:39] offset:256
    ds_write_b128 v13, v[56:59] offset:512
    ds_write_b128 v13, v[28:31] offset:768
    s_mov_b64 exec, 1
    ds_add_u32 v10, v11 offset:20
    s_mov_b64 exec, -1
    s_cmp_lt_u32 s4, 2
    s_cbranch_scc0 L_c20
L_c30:
    ds_read_b32 v12, v10 offset:20
    s_waitcnt lgkmcnt(0)
    v_readfirstlane_b32 s3, v12
    s_cmp_ge_u32 s3, 5
    s_cbranch_scc1 L_c30_x
    s_sub_u32 s95, s95, 1
    s_cbranch_scc0 L_c30
    s_mov_b32 s95, 0
L_c30_x:
    ds_read2st64_b32 v[44:45], v14 offset0:0 offset1:4
    ds_read2st64_b32 v[46:47], v14 offset0:8 offset1:12
    ds_read_b32 v48, v14 offset:4096
    ds_read2st64_b32 v[50:51], v14 offset0:2 offset1:6
    ds_read2st64_b32 v[52:53], v14 offset0:10 offset1:14
    ds_read_b32 v54, v14 offset:4608
    s_waitcnt lgkmcnt(0)
    v_add_f32 v44, v44, v45
    v_add_f32 v46, v46, v47
    v_add_f32 v44, v44, v48
    v_add_f32 v28, v44, v46
    v_add_f32 v50, v50, v51
    v_add_f32 v52, v52, v53
    v_add_f32 v50, v50, v54
    v_add_f32 v30, v50, v52
    s_mov_b64 exec, 1
    ds_add_u32 v10, v11 offset:20
    s_mov_b64 exec, -1
L_c20:
    v_mov_b32 v40, v60
    v_mov_b32 v41, v61
    v_mov_b32 v42, v62
    v_mov_b32 v43, v63
    v_mov_b32_dpp v44, v40 row_shl:4 row_mask:0xf bank_mask:0xf bound_ctrl:0
    v_mov_b32_dpp v45, v41 row_shl:4 row_mask:0xf bank_mask:0xf bound_ctrl:0
    v_mov_b32_dpp v46, v42 row_shl:4 row_mask:0xf bank_mask:0xf bound_ctrl:0
    v_mov_b32_dpp v47, v43 row_shl:4 row_mask:0xf bank_mask:0xf bound_ctrl:0
    v_mov_b32_dpp v48, v40 row_shl:8 row_mask:0xf bank_mask:0xf bound_ctrl:0
    v_mov_b32_dpp v49, v41 row_shl:8 row_mask:0xf bank_mask:0xf bound_ctrl:0
    v_mov_b32_dpp v50, v42 row_shl:8 row_mask:0xf bank_mask:0xf bound_ctrl:0
    v_mov_b32_dpp v51, v43 row_shl:8 row_mask:0xf bank_mask:0xf bound_ctrl:0
    v_mov_b32_dpp v52, v40 row_shl:12 row_mask:0xf bank_mask:0xf bound_ctrl:0
    v_mov_b32_dpp v53, v41 row_shl:12 row_mask:0xf bank_mask:0xf bound_ctrl:0
    v_mov_b32_dpp v54, v42 row_shl:12 row_mask:0xf bank_mask:0xf bound_ctrl:0
    v_mov_b32_dpp v55, v43 row_shl:12 row_mask:0xf bank_mask:0xf bound_ctrl:0
    s_waitcnt lgkmcnt(0)
    v_mfma_f32_16x16x32_bf16 v[32:35], v[40:43], v[64:67], 0
    v_mfma_f32_16x16x32_bf16 v[36:39], v[40:43], v[80:83], 0
    v_mfma_f32_16x16x32_bf16 v[56:59], v[40:43], v[96:99], 0
    v_mfma_f32_16x16x32_bf16 v[60:63], v[40:43], v[112:115], 0
    v_mfma_f32_16x16x32_bf16 v[32:35], v[44:47], v[68:71], v[32:35]
    v_mfma_f32_16x16x32_bf16 v[36:39], v[44:47], v[84:87], v[36:39]
    v_mfma_f32_16x16x32_bf16 v[56:59], v[44:47], v[100:103], v[56:59]
    v_mfma_f32_16x16x32_bf16 v[60:63], v[44:47], v[116:119], v[60:63]
    v_mfma_f32_16x16x32_bf16 v[32:35], v[48:51], v[72:75], v[32:35]
    v_mfma_f32_16x16x32_bf16 v[36:39], v[48:51], v[88:91], v[36:39]
    v_mfma_f32_16x16x32_bf16 v[56:59], v[48:51], v[104:107], v[56:59]
    v_mfma_f32_16x16x32_bf16 v[60:63], v[48:51], v[120:123], v[60:63]
    v_mfma_f32_16x16x32_bf16 v[32:35], v[52:55], v[76:79], v[32:35]
    v_mfma_f32_16x16x32_bf16 v[36:39], v[52:55], v[92:95], v[36:39]
    v_mfma_f32_16x16x32_bf16 v[56:59], v[52:55], v[108:111], v[56:59]
    v_mfma_f32_16x16x32_bf16 v[60:63], v[52:55], v[124:127], v[60:63]
L_c1:
    ds_read_b32 v12, v10 offset:20
    s_waitcnt lgkmcnt(0)
    v_readfirstlane_b32 s3, v12
    s_cmp_ge_u32 s3, 7
    s_cbranch_scc1 L_c1_x
    s_sub_u32 s95, s95, 1
    s_cbranch_scc0 L_c1
    s_mov_b32 s95, 0
L_c1_x:
    s_mov_b64 exec, 0xffff
    ds_write_b128 v13, v[32:35] offset:0
    ds_write_b128 v13, v[36:39] offset:256
    ds_write_b128 v13, v[56:59] offset:512
    ds_write_b128 v13, v[60:63] offset:768
    s_mov_b64 exec, 1
    ds_add_u32 v10, v11 offset:24
    s_mov_b64 exec, -1
    s_cmp_lt_u32 s4, 2
    s_cbranch_scc0 L_c21
L_c31:
    ds_read_b32 v12, v10 offset:24
    s_waitcnt lgkmcnt(0)
    v_readfirstlane_b32 s3, v12
    s_cmp_ge_u32 s3, 5
    s_cbranch_scc1 L_c31_x
    s_sub_u32 s95, s95, 1
    s_cbranch_scc0 L_c31
    s_mov_b32 s95, 0
L_c31_x:
    ds_read2st64_b32 v[44:45], v14 offset0:0 offset1:4
    ds_read2st64_b32 v[46:47], v14 offset0:8 offset1:12
    ds_read_b32 v48, v14 offset:4096
    ds_read2st64_b32 v[50:51], v14 offset0:2 offset1:6
    ds_read2st64_b32 v[52:53], v14 offset0:10 offset1:14
    ds_read_b32 v54, v14 offset:4608
    s_waitcnt lgkmcnt(0)
    v_add_f32 v44, v44, v45
    v_add_f32 v46, v46, v47
    v_add_f32 v44, v44, v48
    v_add_f32 v29, v44, v46
    v_add_f32 v50, v50, v51
    v_add_f32 v52, v52, v53
    v_add_f32 v50, v50, v54
    v_add_f32 v31, v50, v52
    s_mov_b64 exec, 1
    ds_add_u32 v10, v11 offset:24
    s_mov_b64 exec, -1
L_c21:
L_preW:
L_wow:
    ds_read_b32 v12, v10 offset:8
    s_waitcnt lgkmcnt(0)
    v_readfirstlane_b32 s3, v12
    s_cmp_ge_u32 s3, 5
    s_cbranch_scc1 L_wow_x
    s_sleep 4
    s_sub_u32 s95, s95, 1
    s_cbranch_scc0 L_wow
    s_mov_b32 s95, 0
L_wow_x:
    ds_read_b64_tr_b16 v[64:65], v7 offset:0
    ds_read_b64_tr_b16 v[66:67], v8 offset:0
    ds_read_b64_tr_b16 v[68:69], v7 offset:3840
    ds_read_b64_tr_b16 v[70:71], v8 offset:3840
    ds_read_b64_tr_b16 v[72:73], v7 offset:7680
    ds_read_b64_tr_b16 v[74:75], v8 offset:7680
    ds_read_b64_tr_b16 v[76:77], v7 offset:11520
    ds_read_b64_tr_b16 v[78:79], v8 offset:11520
    ds_read_b64_tr_b16 v[80:81], v7 offset:15360
    ds_read_b64_tr_b16 v[82:83], v8 offset:15360
    ds_read_b64_tr_b16 v[84:85], v7 offset:19200
    ds_read_b64_tr_b16 v[86:87], v8 offset:19200
    ds_read_b64_tr_b16 v[88:89], v7 offset:23040
    ds_read_b64_tr_b16 v[90:91], v8 offset:23040
    ds_read_b64_tr_b16 v[92:93], v7 offset:26880
    ds_read_b64_tr_b16 v[94:95], v8 offset:26880
    v_mov_b32 v12, 0
    s_cmp_eq_u32 s60, 2
    s_cbranch_scc0 L_preB
    v_lshlrev_b32 v11, 3, v4
    s_lshl_b32 s3, s4, 5
    v_add_u32 v12, s3, v11
    s_branch L_preD
L_preB:
    s_cmp_eq_u32 s60, 3
    s_cbranch_scc0 L_preR
    s_lshl_b32 s13, s61, 8
    s_add_u32 s13, s13, 96256
    v_mov_b32 v12, v3
    v_lshrrev_b32 v21, 2, v0
    s_branch L_preG0
L_preR:
    s_cmp_eq_u32 s59, -1
    s_cbranch_scc1 L_preD
    v_and_b32 v21, 15, v0
    v_mov_b32 v22, v6
    v_bfe_u32 v23, v21, 2, 1
    v_lshlrev_b32 v12, 7, v23
    v_lshrrev_b32 v23, 3, v21
    v_lshl_add_u32 v12, v23, 6, v12
    v_bfe_u32 v23, v21, 1, 1
    v_lshl_add_u32 v12, v23, 2, v12
    v_lshl_add_u32 v12, v22, 4, v12
    s_mov_b32 s48, s16
    s_mov_b32 s49, s17
    s_mov_b32 s50, 5120
    s_mov_b32 s51, 0x20000
    v_mul_u32_u24 v23, 1280, v22
    v_lshl_add_u32 v23, v21, 1, v23
    s_lshl_b32 s3, s59, 5
    buffer_load_ushort v20, v23, s[48:51], s3 offen
    s_lshl_b32 s13, s59, 8
    s_add_u32 s13, s13, 65536
L_preG0:
    v_and_b32 v11, -16, v12
    v_and_b32 v23, 2, v21
    v_cmp_eq_u32 s[98:99], 0, v23
    v_and_b32 v22, 1, v21
    v_lshlrev_b32 v22, 4, v22
    v_sub_u32 v22, 16, v22
L_preG:
    buffer_load_dwordx4 v[24:27], v11, s[44:47], s13 offen sc1
    s_waitcnt vmcnt(0)
    v_cmp_ne_u32 vcc, s9, v26
    s_cbranch_vccz L_preG_ok
    s_sleep 8
    s_sub_u32 s95, s95, 1
    s_cbranch_scc0 L_preG
    s_mov_b32 s95, 0
L_preG_ok:
    v_cndmask_b32 v24, v25, v24, s[98:99]
    v_lshlrev_b32 v21, v22, v24
    v_and_b32 v21, 0xffff0000, v21
    v_lshlrev_b32 v20, 16, v20
L_preD:
    s_cmp_eq_u32 s4, 0
    s_cbranch_scc0 L_noxid
    s_getreg_b32 s42, hwreg(HW_REG_XCC_ID)
    s_lshl_b32 s13, s5, 12
    s_add_u32 s13, s13, 1114112
    v_lshlrev_b32 v38, 7, v0
    s_mov_b32 exec_hi, 0
L_xid:
    buffer_load_dwordx2 v[40:41], v38, s[44:47], s13 offen sc1
    s_waitcnt vmcnt(0)
    v_cmp_ne_u32 vcc, s9, v41
    s_cbranch_vccz L_xid_ok
    s_sleep 100
    s_sub_u32 s95, s95, 1
    s_cbranch_scc0 L_xid
    s_mov_b32 s95, 0
L_xid_ok:
    v_cmp_ne_u32 vcc, s42, v40
    s_mov_b32 exec_hi, -1
    s_cmp_eq_u64 vcc, 0
    s_cselect_b32 s12, 1, 0
    s_cmp_eq_u32 s95, 0
    s_cselect_b32 s12, 0, s12
    v_mov_b32 v40, s12
    ds_write_b32 v10, v40 offset:16
L_noxid:
    v_mov_b32 v43, s9
    s_waitcnt vmcnt(0) lgkmcnt(0)
    s_setprio 2
    s_barrier
    s_cmp_eq_u32 s4, 0
    s_cbranch_scc0 L_O
    ds_read_b32 v36, v18 offset:524
    ds_read_b32 v37, v18 offset:12
    ds_read_b128 v[96:99], v19 offset:0
    ds_read_b128 v[100:103], v19 offset:512
    ds_read_b128 v[104:107], v19 offset:1024
    ds_read_b128 v[108:111], v19 offset:1536
    ds_read_b128 v[112:115], v19 offset:2048
    ds_read_b128 v[116:119], v19 offset:2560
    ds_read_b128 v[120:123], v19 offset:3072
    ds_read_b128 v[124:127], v19 offset:3584
    s_waitcnt lgkmcnt(8)
    v_max_f32_dpp v38, v36, v36 quad_perm:[1,0,3,2] row_mask:0xf bank_mask:0xf
    s_nop 1
    v_max_f32_dpp v38, v38, v38 quad_perm:[2,3,0,1] row_mask:0xf bank_mask:0xf
    s_nop 1
    v_max_f32_dpp v38, v38, v38 row_half_mirror row_mask:0xf bank_mask:0xf
    v_sub_f32 v36, v36, v38
    v_mul_f32 v36, s58, v36
    v_exp_f32 v36, v36
    s_nop 0
    v_mul_f32 v37, v37, v36
    s_waitcnt lgkmcnt(6)
    v_mul_f32_dpp v56, v36, v96 row_newbcast:0 row_mask:0xf bank_mask:0xf
    v_mul_f32_dpp v57, v36, v100 row_newbcast:0 row_mask:0xf bank_mask:0xf
    v_mul_f32_dpp v58, v36, v97 row_newbcast:0 row_mask:0xf bank_mask:0xf
    v_mul_f32_dpp v59, v36, v101 row_newbcast:0 row_mask:0xf bank_mask:0xf
    v_mul_f32_dpp v60, v36, v98 row_newbcast:0 row_mask:0xf bank_mask:0xf
    v_mul_f32_dpp v61, v36, v102 row_newbcast:0 row_mask:0xf bank_mask:0xf
    v_add_f32_dpp v37, v37, v37 quad_perm:[1,0,3,2] row_mask:0xf bank_mask:0xf
    s_waitcnt lgkmcnt(4)
    v_fmac_f32_dpp v56, v36, v104 row_newbcast:1 row_mask:0xf bank_mask:0xf
    v_fmac_f32_dpp v57, v36, v108 row_newbcast:1 row_mask:0xf bank_mask:0xf
    v_fmac_f32_dpp v58, v36, v105 row_newbcast:1 row_mask:0xf bank_mask:0xf
    v_fmac_f32_dpp v59, v36, v109 row_newbcast:1 row_mask:0xf bank_mask:0xf
    v_fmac_f32_dpp v60, v36, v106 row_newbcast:1 row_mask:0xf bank_mask:0xf
    v_fmac_f32_dpp v61, v36, v110 row_newbcast:1 row_mask:0xf bank_mask:0xf
    v_add_f32_dpp v37, v37, v37 quad_perm:[2,3,0,1] row_mask:0xf bank_mask:0xf
    s_waitcnt lgkmcnt(2)
    v_fmac_f32_dpp v56, v36, v112 row_newbcast:2 row_mask:0xf bank_mask:0xf
    v_fmac_f32_dpp v57, v36, v116 row_newbcast:2 row_mask:0xf bank_mask:0xf
    v_fmac_f32_dpp v58, v36, v113 row_newbcast:2 row_mask:0xf bank_mask:0xf
    v_fmac_f32_dpp v59, v36, v117 row_newbcast:2 row_mask:0xf bank_mask:0xf
    v_fmac_f32_dpp v60, v36, v114 row_newbcast:2 row_mask:0xf bank_mask:0xf
    v_fmac_f32_dpp v61, v36, v118 row_newbcast:2 row_mask:0xf bank_mask:0xf
    v_add_f32_dpp v37, v37, v37 row_half_mirror row_mask:0xf bank_mask:0xf
    s_waitcnt lgkmcnt(0)
    v_fmac_f32_dpp v56, v36, v120 row_newbcast:3 row_mask:0xf bank_mask:0xf
    v_fmac_f32_dpp v57, v36, v124 row_newbcast:3 row_mask:0xf bank_mask:0xf
    v_fmac_f32_dpp v58, v36, v121 row_newbcast:3 row_mask:0xf bank_mask:0xf
    v_fmac_f32_dpp v59, v36, v125 row_newbcast:3 row_mask:0xf bank_mask:0xf
    v_fmac_f32_dpp v60, v36, v122 row_newbcast:3 row_mask:0xf bank_mask:0xf
    v_fmac_f32_dpp v61, v36, v126 row_newbcast:3 row_mask:0xf bank_mask:0xf
    v_rcp_f32 v39, v37
    v_permlane32_swap_b32 v58, v59
    v_permlane32_swap_b32 v56, v60
    v_permlane32_swap_b32 v57, v61
    v_add_f32 v58, v58, v59
    v_add_f32 v56, v56, v60
    v_add_f32 v57, v57, v61
    v_mul_f32 v58, v58, v39
    v_mul_f32 v56, v56, v39
    v_mul_f32 v57, v57, v39
    v_mov_b32 v59, v58
    v_cvt_pk_bf16_f32 v40, v56, v57
    v_cvt_pk_bf16_f32 v42, v56, v57
    v_permlane32_swap_b32 v58, v59
    s_nop 0
    v_permlane32_swap_b32 v40, v42
    v_cvt_pk_bf16_f32 v41, v58, v59
    v_cndmask_b32 v40, v40, v38, s[56:57]
    v_cndmask_b32 v41, v41, v37, s[56:57]
    s_mov_b32 exec_hi, 1
    s_cmp_eq_u32 s12, 1
    s_cbranch_scc0 L_slowrec
    buffer_store_dwordx4 v[40:43], v1, s[44:47], s15 offen
    s_branch L_recdone
L_slowrec:
    buffer_store_dwordx4 v[40:43], v1, s[44:47], s15 offen sc1
L_recdone:
    s_mov_b32 exec_hi, -1
L_O:
    s_mov_b64 exec, s[96:97]
L_opoll:
    buffer_load_dwordx4 v[44:47], v1, s[44:47], s14 offen sc1
    s_waitcnt vmcnt(0)
    v_cmp_ne_u32 vcc, s9, v47
    s_cbranch_vccz L_opoll_ok
    s_sleep 1
    s_sub_u32 s95, s95, 1
    s_cbranch_scc0 L_opoll
    s_mov_b32 s95, 0
L_opoll_ok:
    v_mov_b32 v47, 0
    ds_write_b128 v15, v[44:47]
    s_mov_b64 exec, -1
    s_waitcnt lgkmcnt(0)
    s_barrier
    ds_read_b64 v[36:37], v17
    ds_read_b128 v[96:99], v16 offset:0
    ds_read_b128 v[100:103], v16 offset:64
    ds_read_b128 v[104:107], v16 offset:128
    ds_read_b128 v[108:111], v16 offset:192
    ds_read_b128 v[112:115], v16 offset:256
    ds_read_b128 v[116:119], v16 offset:320
    ds_read_b128 v[120:123], v16 offset:384
    ds_read_b128 v[124:127], v16 offset:448
    v_mov_b32 v51, s9
    s_mov_b32 s16, 0x07060501
    s_mov_b32 s17, 0x07060502
    s_mov_b32 s18, 0x07060503
    s_waitcnt lgkmcnt(8)
    v_max_f32_dpp v38, v36, v36 quad_perm:[1,0,3,2] row_mask:0xf bank_mask:0xf
    s_waitcnt lgkmcnt(7)
    v_mfma_f32_16x16x32_bf16 v[40:43], v[96:99], v[64:67], 0
    v_sub_f32 v36, v36, v38
    v_mul_f32 v36, s58, v36
    s_waitcnt lgkmcnt(6)
    v_mfma_f32_16x16x32_bf16 v[40:43], v[100:103], v[68:71], v[40:43]
    v_exp_f32 v36, v36
    s_waitcnt lgkmcnt(5)
    v_mfma_f32_16x16x32_bf16 v[40:43], v[104:107], v[72:75], v[40:43]
    v_mul_f32 v36, v36, v37
    s_waitcnt lgkmcnt(4)
    v_mfma_f32_16x16x32_bf16 v[40:43], v[108:111], v[76:79], v[40:43]
    v_add_f32_dpp v37, v36, v36 quad_perm:[1,0,3,2] row_mask:0xf bank_mask:0xf
    s_waitcnt lgkmcnt(3)
    v_mfma_f32_16x16x32_bf16 v[40:43], v[112:115], v[80:83], v[40:43]
    v_rcp_f32 v37, v37
    s_waitcnt lgkmcnt(2)
    v_mfma_f32_16x16x32_bf16 v[40:43], v[116:119], v[84:87], v[40:43]
    v_mul_f32 v36, v36, v37
    s_waitcnt lgkmcnt(1)
    v_mfma_f32_16x16x32_bf16 v[40:43], v[120:123], v[88:91], v[40:43]
    s_waitcnt lgkmcnt(0)
    v_mfma_f32_16x16x32_bf16 v[40:43], v[124:127], v[92:95], v[40:43]
    s_nop 7
    v_mul_f32_dpp v44, v36, v40 quad_perm:[0,0,0,0] row_mask:0xf bank_mask:0xf
    v_mul_f32_dpp v45, v36, v42 quad_perm:[2,2,2,2] row_mask:0xf bank_mask:0xf
    s_nop 0
    v_fmac_f32_dpp v44, v36, v41 quad_perm:[1,1,1,1] row_mask:0xf bank_mask:0xf
    v_fmac_f32_dpp v45, v36, v43 quad_perm:[3,3,3,3] row_mask:0xf bank_mask:0xf
    s_nop 0
    v_permlane16_swap_b32 v44, v46
    v_permlane16_swap_b32 v45, v47
    v_perm_b32 v48, v44, v47, s16
    v_perm_b32 v49, v45, v47, s17
    v_perm_b32 v50, v46, v47, s18
    s_mov_b64 exec, 0xffff
    buffer_store_dwordx4 v[48:51], v1, s[44:47], s43 offen sc1
    s_mov_b64 exec, -1
    s_mul_i32 s14, s5, 10240
    s_add_u32 s14, s14, 1024000
    s_cmp_eq_u32 s60, 3
    s_cbranch_scc1 L_F2
    s_cmp_eq_u32 s60, 2
    s_cbranch_scc0 L_R
    ds_read_b64_tr_b16 v[64:65], v9 offset:0
    ds_read_b64_tr_b16 v[66:67], v9 offset:256
    ds_read_b64_tr_b16 v[68:69], v9 offset:2048
    ds_read_b64_tr_b16 v[70:71], v9 offset:2304
    ds_read_b64_tr_b16 v[72:73], v9 offset:4096
    ds_read_b64_tr_b16 v[74:75], v9 offset:4352
    ds_read_b64_tr_b16 v[76:77], v9 offset:6144
    ds_read_b64_tr_b16 v[78:79], v9 offset:6400
    ds_read_b64_tr_b16 v[80:81], v9 offset:32
    ds_read_b64_tr_b16 v[82:83], v9 offset:288
    ds_read_b64_tr_b16 v[84:85], v9 offset:2080
    ds_read_b64_tr_b16 v[86:87], v9 offset:2336
    ds_read_b64_tr_b16 v[88:89], v9 offset:4128
    ds_read_b64_tr_b16 v[90:91], v9 offset:4384
    ds_read_b64_tr_b16 v[92:93], v9 offset:6176
    ds_read_b64_tr_b16 v[94:95], v9 offset:6432
    ds_read_b64_tr_b16 v[96:97], v9 offset:8192
    ds_read_b64_tr_b16 v[98:99], v9 offset:8448
    ds_read_b64_tr_b16 v[100:101], v9 offset:10240
    ds_read_b64_tr_b16 v[102:103], v9 offset:10496
    ds_read_b64_tr_b16 v[104:105], v9 offset:12288
    ds_read_b64_tr_b16 v[106:107], v9 offset:12544
    ds_read_b64_tr_b16 v[108:109], v9 offset:14336
    ds_read_b64_tr_b16 v[110:111], v9 offset:14592
    ds_read_b64_tr_b16 v[112:113], v9 offset:8224
    ds_read_b64_tr_b16 v[114:115], v9 offset:8480
    ds_read_b64_tr_b16 v[116:117], v9 offset:10272
    ds_read_b64_tr_b16 v[118:119], v9 offset:10528
    ds_read_b64_tr_b16 v[120:121], v9 offset:12320
    ds_read_b64_tr_b16 v[122:123], v9 offset:12576
    ds_read_b64_tr_b16 v[124:125], v9 offset:14368
    ds_read_b64_tr_b16 v[126:127], v9 offset:14624
    ds_read_b32 v36, v10 offset:16
    s_mul_i32 s42, s5, 6
    s_sub_u32 s42, s61, s42
    s_lshl_b32 s42, s42, 1
    s_add_u32 s42, s42, s4
    s_lshl_b32 s42, s42, 3
    s_lshl_b32 s3, s5, 7
    s_add_u32 s42, s42, s3
    s_add_u32 s42, s42, 8192
    s_waitcnt lgkmcnt(0)
    v_readfirstlane_b32 s12, v36
    s_add_u32 s3, s63, s14
    s_mov_b32 s13, 0x3f803f80
L_xpoll:
    buffer_load_dwordx4 v[48:51], v2, s[44:47], s3 offen sc1
    buffer_load_dwordx4 v[52:55], v2, s[44:47], s3 offen offset:128 sc1
    s_waitcnt vmcnt(0)
    v_xor_b32 v39, s9, v50
    v_bitop3_b32 v39, v39, v54, s9 bitop3:0xf6
    v_cmp_ne_u32 vcc, 0, v39
    s_cbranch_vccz L_xpoll_ok
    s_sub_u32 s95, s95, 1
    s_cbranch_scc0 L_xpoll
    s_mov_b32 s95, 0
L_xpoll_ok:
    v_lshlrev_b32 v56, 16, v48
    v_and_b32 v57, 0xffff0000, v48
    v_lshlrev_b32 v58, 16, v49
    v_and_b32 v59, 0xffff0000, v49
    v_lshlrev_b32 v60, 16, v52
    v_and_b32 v61, 0xffff0000, v52
    v_lshlrev_b32 v62, 16, v53
    v_and_b32 v63, 0xffff0000, v53
    v_pk_mul_f32 v[56:57], v[56:57], v[20:21]
    v_pk_mul_f32 v[58:59], v[58:59], v[22:23]
    v_pk_mul_f32 v[60:61], v[60:61], v[24:25]
    v_pk_mul_f32 v[62:63], v[62:63], v[26:27]
    v_cvt_pk_bf16_f32 v40, v56, v57
    v_cvt_pk_bf16_f32 v41, v58, v59
    v_cvt_pk_bf16_f32 v42, v60, v61
    v_cvt_pk_bf16_f32 v43, v62, v63
    s_waitcnt lgkmcnt(0)
    s_nop 0
    v_mfma_f32_16x16x32_bf16 v[20:23], v[40:43], v[64:67], 0
    v_mov_b32_dpp v44, v40 row_shl:4 row_mask:0xf bank_mask:0xf bound_ctrl:0
    v_mov_b32_dpp v45, v41 row_shl:4 row_mask:0xf bank_mask:0xf bound_ctrl:0
    v_mfma_f32_16x16x32_bf16 v[24:27], v[40:43], v[80:83], 0
    v_mov_b32_dpp v46, v42 row_shl:4 row_mask:0xf bank_mask:0xf bound_ctrl:0
    v_mov_b32_dpp v47, v43 row_shl:4 row_mask:0xf bank_mask:0xf bound_ctrl:0
    v_mfma_f32_16x16x32_bf16 v[32:35], v[40:43], v[96:99], 0
    v_dot2_f32_bf16 v56, v48, s13, 0
    v_dot2_f32_bf16 v57, v48, v48, 0
    v_dot2_f32_bf16 v56, v49, s13, v56
    v_dot2_f32_bf16 v57, v49, v49, v57
    v_mfma_f32_16x16x32_bf16 v[36:39], v[40:43], v[112:115], 0
    v_dot2_f32_bf16 v56, v52, s13, v56
    v_dot2_f32_bf16 v57, v52, v52, v57
    v_dot2_f32_bf16 v56, v53, s13, v56
    v_dot2_f32_bf16 v57, v53, v53, v57
    v_mfma_f32_16x16x32_bf16 v[20:23], v[44:47], v[68:71], v[20:23]
    v_mov_b32_dpp v48, v40 row_shl:8 row_mask:0xf bank_mask:0xf bound_ctrl:0
    v_mov_b32_dpp v49, v41 row_shl:8 row_mask:0xf bank_mask:0xf bound_ctrl:0
    v_mfma_f32_16x16x32_bf16 v[24:27], v[44:47], v[84:87], v[24:27]
    v_mov_b32_dpp v50, v42 row_shl:8 row_mask:0xf bank_mask:0xf bound_ctrl:0
    v_mov_b32_dpp v51, v43 row_shl:8 row_mask:0xf bank_mask:0xf bound_ctrl:0
    v_mfma_f32_16x16x32_bf16 v[32:35], v[44:47], v[100:103], v[32:35]
    v_add_f32_dpp v56, v56, v56 row_ror:4 row_mask:0xf bank_mask:0xf
    v_add_f32_dpp v57, v57, v57 row_ror:4 row_mask:0xf bank_mask:0xf
    v_mfma_f32_16x16x32_bf16 v[36:39], v[44:47], v[116:119], v[36:39]
    v_add_f32_dpp v56, v56, v56 row_ror:8 row_mask:0xf bank_mask:0xf
    v_add_f32_dpp v57, v57, v57 row_ror:8 row_mask:0xf bank_mask:0xf
    v_mfma_f32_16x16x32_bf16 v[20:23], v[48:51], v[72:75], v[20:23]
    v_mov_b32_dpp v52, v40 row_shl:12 row_mask:0xf bank_mask:0xf bound_ctrl:0
    v_mov_b32_dpp v53, v41 row_shl:12 row_mask:0xf bank_mask:0xf bound_ctrl:0
    v_mfma_f32_16x16x32_bf16 v[24:27], v[48:51], v[88:91], v[24:27]
    v_mov_b32_dpp v54, v42 row_shl:12 row_mask:0xf bank_mask:0xf bound_ctrl:0
    v_mov_b32_dpp v55, v43 row_shl:12 row_mask:0xf bank_mask:0xf bound_ctrl:0
    v_mfma_f32_16x16x32_bf16 v[32:35], v[48:51], v[104:107], v[32:35]
    v_permlane16_swap_b32 v56, v57
    v_add_f32 v56, v56, v57
    v_mfma_f32_16x16x32_bf16 v[36:39], v[48:51], v[120:123], v[36:39]
    v_mov_b32 v58, v56
    v_mfma_f32_16x16x32_bf16 v[20:23], v[52:55], v[76:79], v[20:23]
    s_nop 0
    v_permlane32_swap_b32 v56, v58
    v_add_f32 v56, v56, v58
    v_mfma_f32_16x16x32_bf16 v[24:27], v[52:55], v[92:95], v[24:27]
    v_mov_b32 v57, v56
    v_mfma_f32_16x16x32_bf16 v[32:35], v[52:55], v[108:111], v[32:35]
    s_nop 0
    v_permlane16_swap_b32 v56, v57
    v_mfma_f32_16x16x32_bf16 v[36:39], v[52:55], v[124:127], v[36:39]
    s_mov_b64 exec, 15
    ds_write_b64 v12, v[56:57] offset:128
    s_lshl_b32 s3, s61, 1
    s_add_u32 s3, s3, s4
    s_lshl_b32 s3, s3, 8
    s_add_u32 s3, s3, 20480
    s_mov_b64 exec, 0xffff
    ds_write_b128 v13, v[20:23] offset:0
    ds_write_b128 v13, v[24:27] offset:256
    ds_write_b128 v13, v[32:35] offset:512
    ds_write_b128 v13, v[36:39] offset:768
    s_mov_b64 exec, -1
    v_mov_b32 v58, s9
    v_mov_b32 v59, s9
    s_waitcnt lgkmcnt(0)
    s_barrier
    s_cmp_lt_u32 s4, 2
    s_cbranch_scc0 L_tend
    ds_read2_b64 v[64:67], v11 offset0:16 offset1:20
    ds_read2_b64 v[68:71], v11 offset0:24 offset1:28
    ds_read_b64 v[72:73], v11 offset:256
    ds_read2st64_b32 v[40:41], v14 offset0:0 offset1:4
    ds_read2st64_b32 v[42:43], v14 offset0:8 offset1:12
    ds_read_b32 v44, v14 offset:4096
    ds_read2st64_b32 v[46:47], v14 offset0:2 offset1:6
    ds_read2st64_b32 v[48:49], v14 offset0:10 offset1:14
    ds_read_b32 v50, v14 offset:4608
    v_mov_b32 v52, 0xc0135761
    v_mov_b32 v74, 0x3acccccd
    s_waitcnt lgkmcnt(6)
    v_pk_add_f32 v[64:65], v[64:65], v[66:67]
    v_pk_add_f32 v[68:69], v[68:69], v[70:71]
    v_pk_add_f32 v[72:73], v[72:73], v[64:65]
    v_pk_add_f32 v[72:73], v[72:73], v[68:69]
    v_pk_mul_f32 v[72:73], v[72:73], v[74:75] op_sel_hi:[1,0]
    v_fma_f32 v38, -v72, v72, v73
    v_max_f32 v38, 0, v38
    v_cvt_pk_bf16_f32 v72, v72, v38
    s_waitcnt lgkmcnt(3)
    v_and_b32 v38, 0xffff0000, v72
    v_add_f32 v40, v40, v41
    v_add_f32 v38, 0x3727c5ac, v38
    v_add_f32 v42, v42, v43
    v_cvt_pk_bf16_f32 v38, v38, v38
    v_lshlrev_b32 v72, 16, v72
    v_lshlrev_b32 v38, 16, v38
    v_sqrt_f32 v38, v38
    v_add_f32 v40, v40, v44
    v_cvt_pk_bf16_f32 v38, v38, v38
    v_fma_f32 v42, -v72, v28, v42
    v_lshlrev_b32 v38, 16, v38
    v_rcp_f32 v38, v38
    v_add_f32 v40, v40, v42
    s_waitcnt lgkmcnt(0)
    v_fma_f32 v40, v40, v38, v29
    v_add_f32 v46, v46, v47
    v_mul_f32 v41, v40, v40
    v_add_f32 v48, v48, v49
    v_fmac_f32 v52, 0xbdd2d3e8, v41
    v_add_f32 v46, v46, v50
    v_mul_f32 v52, v52, v40
    v_fma_f32 v48, -v72, v30, v48
    v_exp_f32 v52, v52
    v_add_f32 v46, v46, v48
    v_add_f32 v52, 1.0, v52
    v_fma_f32 v46, v46, v38, v31
    v_rcp_f32 v52, v52
    v_mul_f32 v40, v40, v46
    v_mul_f32 v40, v40, v52
    s_nop 1
    v_mov_b32_dpp v57, v40 row_shl:4 row_mask:0xf bank_mask:0xf bound_ctrl:0
    v_cvt_pk_bf16_f32 v56, v40, v57
    s_nop 1
    v_mov_b32_dpp v57, v56 row_shl:8 row_mask:0xf bank_mask:0xf bound_ctrl:0
    s_mov_b32 exec_lo, 0x000f000f
    s_mov_b32 exec_hi, 0x000f000f
    buffer_store_dwordx4 v[56:59], v3, s[44:47], s3 offen sc1
    s_mov_b64 exec, 1
    s_cmp_eq_u32 s12, 1
    s_cbranch_scc0 L_slowgf
    buffer_store_dwordx2 v[58:59], v10, s[44:47], s42 offen
    s_branch L_tend
L_slowgf:
    buffer_store_dwordx2 v[58:59], v10, s[44:47], s42 offen sc1
    s_branch L_tend
L_R:
    s_cmp_eq_u32 s59, -1
    s_cbranch_scc1 L_tend
    s_lshl_b32 s3, s59, 13
    s_add_u32 s3, s3, 368640
    s_add_u32 s13, s3, 4096
    s_lshl_b32 s59, s59, 8
    s_add_u32 s14, s14, s59
    v_mov_b32 v42, s9
    v_mov_b32 v43, s9
    s_mov_b32 s15, 15
    s_mov_b32 s16, 0x0c04000c
    s_mov_b32 s17, 0x04020100
    ds_read_b32 v36, v10 offset:16
    s_waitcnt lgkmcnt(0)
    v_readfirstlane_b32 s12, v36
L_ypoll:
    s_bitcmp1_b32 s15, 0
    s_cbranch_scc0 L_yl0
    buffer_load_dwordx4 v[64:67], v1, s[44:47], s3 offen offset:0 sc1
    buffer_load_dwordx4 v[68:71], v1, s[44:47], s3 offen offset:1024 sc1
L_yl0:
    s_bitcmp1_b32 s15, 1
    s_cbranch_scc0 L_yl1
    buffer_load_dwordx4 v[72:75], v1, s[44:47], s3 offen offset:2048 sc1
    buffer_load_dwordx4 v[76:79], v1, s[44:47], s3 offen offset:3072 sc1
L_yl1:
    s_bitcmp1_b32 s15, 2
    s_cbranch_scc0 L_yl2
    buffer_load_dwordx4 v[80:83], v1, s[44:47], s13 offen offset:0 sc1
    buffer_load_dwordx4 v[84:87], v1, s[44:47], s13 offen offset:1024 sc1
L_yl2:
    s_bitcmp1_b32 s15, 3
    s_cbranch_scc0 L_yl3
    buffer_load_dwordx4 v[88:91], v1, s[44:47], s13 offen offset:2048 sc1
    buffer_load_dwordx4 v[92:95], v1, s[44:47], s13 offen offset:3072 sc1
L_yl3:
    s_waitcnt vmcnt(0)
    s_bitcmp1_b32 s15, 0
    s_cbranch_scc0 L_yc0
    v_xor_b32 v36, s9, v67
    v_perm_b32 v37, v65, v64, s16
    v_bitop3_b32 v36, v36, v71, s9 bitop3:0xf6
    v_perm_b32 v38, v69, v68, s16
    v_cmp_ne_u32 vcc, 0, v36
    v_perm_b32 v67, v66, v37, s17
    v_perm_b32 v71, v70, v38, s17
    s_cbranch_vccnz L_yc0
    v_pk_add_f32 v[64:65], v[64:65], v[68:69]
    s_bitset0_b32 s15, 0
    v_pk_add_f32 v[66:67], v[66:67], v[70:71]
L_yc0:
    s_bitcmp1_b32 s15, 1
    s_cbranch_scc0 L_yc1
    v_xor_b32 v36, s9, v75
    v_perm_b32 v37, v73, v72, s16
    v_bitop3_b32 v36, v36, v79, s9 bitop3:0xf6
    v_perm_b32 v38, v77, v76, s16
    v_cmp_ne_u32 vcc, 0, v36
    v_perm_b32 v75, v74, v37, s17
    v_perm_b32 v79, v78, v38, s17
    s_cbranch_vccnz L_yc1
    v_pk_add_f32 v[72:73], v[72:73], v[76:77]
    s_bitset0_b32 s15, 1
    v_pk_add_f32 v[74:75], v[74:75], v[78:79]
L_yc1:
    s_bitcmp1_b32 s15, 2
    s_cbranch_scc0 L_yc2
    v_xor_b32 v36, s9, v83
    v_perm_b32 v37, v81, v80, s16
    v_bitop3_b32 v36, v36, v87, s9 bitop3:0xf6
    v_perm_b32 v38, v85, v84, s16
    v_cmp_ne_u32 vcc, 0, v36
    v_perm_b32 v83, v82, v37, s17
    v_perm_b32 v87, v86, v38, s17
    s_cbranch_vccnz L_yc2
    v_pk_add_f32 v[80:81], v[80:81], v[84:85]
    s_bitset0_b32 s15, 2
    v_pk_add_f32 v[82:83], v[82:83], v[86:87]
L_yc2:
    s_bitcmp1_b32 s15, 3
    s_cbranch_scc0 L_yc3
    v_xor_b32 v36, s9, v91
    v_perm_b32 v37, v89, v88, s16
    v_bitop3_b32 v36, v36, v95, s9 bitop3:0xf6
    v_perm_b32 v38, v93, v92, s16
    v_cmp_ne_u32 vcc, 0, v36
    v_perm_b32 v91, v90, v37, s17
    v_perm_b32 v95, v94, v38, s17
    s_cbranch_vccnz L_yc3
    v_pk_add_f32 v[88:89], v[88:89], v[92:93]
    s_bitset0_b32 s15, 3
    v_pk_add_f32 v[90:91], v[90:91], v[94:95]
L_yc3:
    s_cmp_eq_u32 s15, 0
    s_cbranch_scc1 L_yok
    s_sleep 1
    s_sub_u32 s95, s95, 1
    s_cbranch_scc0 L_ypoll
    s_mov_b32 s95, 0
L_yok:
    v_pk_add_f32 v[64:65], v[64:65], v[72:73]
    v_pk_add_f32 v[80:81], v[80:81], v[88:89]
    v_pk_add_f32 v[66:67], v[66:67], v[74:75]
    v_pk_add_f32 v[82:83], v[82:83], v[90:91]
    v_pk_add_f32 v[64:65], v[64:65], v[80:81]
    v_pk_add_f32 v[66:67], v[66:67], v[82:83]
    s_nop 0
    v_permlane16_swap_b32 v64, v65
    v_permlane16_swap_b32 v66, v67
    v_add_f32 v64, v64, v65
    v_add_f32 v66, v66, v67
    s_nop 1
    v_permlane32_swap_b32 v64, v66
    v_add_f32 v44, v64, v66
    v_fma_f32 v44, v44, v21, v20
    s_nop 1
    v_mov_b32_dpp v46, v44 quad_perm:[1,1,3,3] row_mask:0xf bank_mask:0xf
    v_cvt_pk_bf16_f32 v40, v44, v46
    s_nop 1
    v_mov_b32_dpp v41, v40 quad_perm:[2,2,2,2] row_mask:0xf bank_mask:0xf
    s_mov_b32 exec_lo, 0x11111111
    s_mov_b32 exec_hi, 0x11111111
    s_cmp_eq_u32 s12, 1
    s_cbranch_scc0 L_slowx1
    buffer_store_dwordx4 v[40:43], v12, s[44:47], s14 offen
    s_branch L_x1done
L_slowx1:
    buffer_store_dwordx4 v[40:43], v12, s[44:47], s14 offen sc1
L_x1done:
    s_or_b32 s59, s59, s5
    s_cbranch_scc1 L_tend
    s_mov_b64 exec, 1
    buffer_store_dword v42, v10, s[44:47], 0 offen sc1
    s_branch L_tend
L_F2:
    s_cmp_eq_u32 s4, 4
    s_cbranch_scc1 L_tend
    ds_read_b64_tr_b16 v[64:65], v9 offset:0
    ds_read_b64_tr_b16 v[66:67], v9 offset:128
    ds_read_b64_tr_b16 v[68:69], v9 offset:1024
    ds_read_b64_tr_b16 v[70:71], v9 offset:1152
    ds_read_b64_tr_b16 v[72:73], v9 offset:2048
    ds_read_b64_tr_b16 v[74:75], v9 offset:2176
    ds_read_b64_tr_b16 v[76:77], v9 offset:3072
    ds_read_b64_tr_b16 v[78:79], v9 offset:3200
    ds_read_b64_tr_b16 v[80:81], v9 offset:4096
    ds_read_b64_tr_b16 v[82:83], v9 offset:4224
    ds_read_b64_tr_b16 v[84:85], v9 offset:5120
    ds_read_b64_tr_b16 v[86:87], v9 offset:5248
    ds_read_b64_tr_b16 v[88:89], v9 offset:6144
    ds_read_b64_tr_b16 v[90:91], v9 offset:6272
    ds_read_b64_tr_b16 v[92:93], v9 offset:7168
    ds_read_b64_tr_b16 v[94:95], v9 offset:7296
    ds_read_b64_tr_b16 v[96:97], v9 offset:8192
    ds_read_b64_tr_b16 v[98:99], v9 offset:8320
    ds_read_b64_tr_b16 v[100:101], v9 offset:9216
    ds_read_b64_tr_b16 v[102:103], v9 offset:9344
    ds_read_b64_tr_b16 v[104:105], v9 offset:10240
    ds_read_b64_tr_b16 v[106:107], v9 offset:10368
    ds_read_b64_tr_b16 v[108:109], v9 offset:11264
    ds_read_b64_tr_b16 v[110:111], v9 offset:11392
    s_lshl_b32 s3, s61, 8
    s_add_u32 s14, s14, s3
L_x2poll:
    buffer_load_dwordx4 v[24:27], v11, s[44:47], s14 offen sc1
    s_waitcnt vmcnt(0)
    v_cmp_ne_u32 vcc, s9, v26
    s_cbranch_vccz L_x2poll_ok
    s_sleep 2
    s_sub_u32 s95, s95, 1
    s_cbranch_scc0 L_x2poll
    s_mov_b32 s95, 0
L_x2poll_ok:
    v_cndmask_b32 v24, v25, v24, s[98:99]
    v_lshlrev_b32 v20, v22, v24
    v_and_b32 v20, 0xffff0000, v20
    s_mul_i32 s3, s4, 6144
    s_add_u32 s3, s3, 20480
    s_add_u32 s13, s3, 4096
    s_lshl_b32 s42, s61, 5
    v_lshrrev_b32 v23, 2, v0
    v_lshlrev_b32 v23, 1, v23
    v_mul_u32_u24 v24, 1280, v4
    v_add_u32 v23, v23, v24
    s_lshl_b32 s14, s5, 7
    s_add_u32 s14, s14, 8192
    v_lshlrev_b32 v25, 3, v0
    s_mov_b64 exec, 0xfff
L_gfpoll:
    buffer_load_dword v26, v25, s[44:47], s14 offen sc1
    s_waitcnt vmcnt(0)
    v_cmp_ne_u32 vcc, s9, v26
    s_cbranch_vccz L_gfpoll_ok
    s_sub_u32 s95, s95, 1
    s_cbranch_scc0 L_gfpoll
    s_mov_b32 s95, 0
L_gfpoll_ok:
    s_mov_b64 exec, -1
L_gpoll:
    buffer_load_dwordx4 v[36:39], v2, s[44:47], s3 offen offset:0 sc1
    buffer_load_dwordx4 v[40:43], v2, s[44:47], s3 offen offset:128 sc1
    buffer_load_dwordx4 v[44:47], v2, s[44:47], s3 offen offset:2048 sc1
    buffer_load_dwordx4 v[48:51], v2, s[44:47], s3 offen offset:2176 sc1
    buffer_load_dwordx4 v[52:55], v2, s[44:47], s13 offen offset:0 sc1
    buffer_load_dwordx4 v[56:59], v2, s[44:47], s13 offen offset:128 sc1
    s_waitcnt vmcnt(0)
    v_xor_b32 v60, s9, v38
    v_bitop3_b32 v60, v60, v42, s9 bitop3:0xf6
    v_bitop3_b32 v60, v60, v46, s9 bitop3:0xf6
    v_bitop3_b32 v60, v60, v50, s9 bitop3:0xf6
    v_bitop3_b32 v60, v60, v54, s9 bitop3:0xf6
    v_bitop3_b32 v60, v60, v58, s9 bitop3:0xf6
    v_cmp_ne_u32 vcc, 0, v60
    s_cbranch_vccz L_gpoll_ok
    s_sub_u32 s95, s95, 1
    s_cbranch_scc0 L_gpoll
    s_mov_b32 s95, 0
L_gpoll_ok:
    v_mov_b32 v112, v36
    v_mov_b32 v113, v37
    v_mov_b32 v114, v40
    v_mov_b32 v115, v41
    v_mov_b32_dpp v116, v36 row_shl:4 row_mask:0xf bank_mask:0xf bound_ctrl:0
    v_mov_b32_dpp v117, v37 row_shl:4 row_mask:0xf bank_mask:0xf bound_ctrl:0
    v_mov_b32_dpp v118, v40 row_shl:4 row_mask:0xf bank_mask:0xf bound_ctrl:0
    v_mov_b32_dpp v119, v41 row_shl:4 row_mask:0xf bank_mask:0xf bound_ctrl:0
    v_mfma_f32_16x16x32_bf16 v[60:63], v[112:115], v[64:67], 0
    v_mov_b32_dpp v120, v36 row_shl:8 row_mask:0xf bank_mask:0xf bound_ctrl:0
    v_mov_b32_dpp v121, v37 row_shl:8 row_mask:0xf bank_mask:0xf bound_ctrl:0
    v_mov_b32_dpp v122, v40 row_shl:8 row_mask:0xf bank_mask:0xf bound_ctrl:0
    v_mov_b32_dpp v123, v41 row_shl:8 row_mask:0xf bank_mask:0xf bound_ctrl:0
    v_mfma_f32_16x16x32_bf16 v[60:63], v[116:119], v[68:71], v[60:63]
    v_mov_b32_dpp v124, v36 row_shl:12 row_mask:0xf bank_mask:0xf bound_ctrl:0
    v_mov_b32_dpp v125, v37 row_shl:12 row_mask:0xf bank_mask:0xf bound_ctrl:0
    v_mov_b32_dpp v126, v40 row_shl:12 row_mask:0xf bank_mask:0xf bound_ctrl:0
    v_mov_b32_dpp v127, v41 row_shl:12 row_mask:0xf bank_mask:0xf bound_ctrl:0
    v_mfma_f32_16x16x32_bf16 v[60:63], v[120:123], v[72:75], v[60:63]
    v_mov_b32 v112, v44
    v_mov_b32 v113, v45
    v_mov_b32 v114, v48
    v_mov_b32 v115, v49
    v_mfma_f32_16x16x32_bf16 v[60:63], v[124:127], v[76:79], v[60:63]
    v_mov_b32_dpp v116, v44 row_shl:4 row_mask:0xf bank_mask:0xf bound_ctrl:0
    v_mov_b32_dpp v117, v45 row_shl:4 row_mask:0xf bank_mask:0xf bound_ctrl:0
    v_mov_b32_dpp v118, v48 row_shl:4 row_mask:0xf bank_mask:0xf bound_ctrl:0
    v_mov_b32_dpp v119, v49 row_shl:4 row_mask:0xf bank_mask:0xf bound_ctrl:0
    v_mfma_f32_16x16x32_bf16 v[60:63], v[112:115], v[80:83], v[60:63]
    v_mov_b32_dpp v120, v44 row_shl:8 row_mask:0xf bank_mask:0xf bound_ctrl:0
    v_mov_b32_dpp v121, v45 row_shl:8 row_mask:0xf bank_mask:0xf bound_ctrl:0
    v_mov_b32_dpp v122, v48 row_shl:8 row_mask:0xf bank_mask:0xf bound_ctrl:0
    v_mov_b32_dpp v123, v49 row_shl:8 row_mask:0xf bank_mask:0xf bound_ctrl:0
    v_mfma_f32_16x16x32_bf16 v[60:63], v[116:119], v[84:87], v[60:63]
    v_mov_b32_dpp v124, v44 row_shl:12 row_mask:0xf bank_mask:0xf bound_ctrl:0
    v_mov_b32_dpp v125, v45 row_shl:12 row_mask:0xf bank_mask:0xf bound_ctrl:0
    v_mov_b32_dpp v126, v48 row_shl:12 row_mask:0xf bank_mask:0xf bound_ctrl:0
    v_mov_b32_dpp v127, v49 row_shl:12 row_mask:0xf bank_mask:0xf bound_ctrl:0
    v_mfma_f32_16x16x32_bf16 v[60:63], v[120:123], v[88:91], v[60:63]
    v_mov_b32 v112, v52
    v_mov_b32 v113, v53
    v_mov_b32 v114, v56
    v_mov_b32 v115, v57
    v_mfma_f32_16x16x32_bf16 v[60:63], v[124:127], v[92:95], v[60:63]
    v_mov_b32_dpp v116, v52 row_shl:4 row_mask:0xf bank_mask:0xf bound_ctrl:0
    v_mov_b32_dpp v117, v53 row_shl:4 row_mask:0xf bank_mask:0xf bound_ctrl:0
    v_mov_b32_dpp v118, v56 row_shl:4 row_mask:0xf bank_mask:0xf bound_ctrl:0
    v_mov_b32_dpp v119, v57 row_shl:4 row_mask:0xf bank_mask:0xf bound_ctrl:0
    v_mfma_f32_16x16x32_bf16 v[60:63], v[112:115], v[96:99], v[60:63]
    v_mov_b32_dpp v120, v52 row_shl:8 row_mask:0xf bank_mask:0xf bound_ctrl:0
    v_mov_b32_dpp v121, v53 row_shl:8 row_mask:0xf bank_mask:0xf bound_ctrl:0
    v_mov_b32_dpp v122, v56 row_shl:8 row_mask:0xf bank_mask:0xf bound_ctrl:0
    v_mov_b32_dpp v123, v57 row_shl:8 row_mask:0xf bank_mask:0xf bound_ctrl:0
    v_mfma_f32_16x16x32_bf16 v[60:63], v[116:119], v[100:103], v[60:63]
    v_mov_b32_dpp v124, v52 row_shl:12 row_mask:0xf bank_mask:0xf bound_ctrl:0
    v_mov_b32_dpp v125, v53 row_shl:12 row_mask:0xf bank_mask:0xf bound_ctrl:0
    v_mov_b32_dpp v126, v56 row_shl:12 row_mask:0xf bank_mask:0xf bound_ctrl:0
    v_mov_b32_dpp v127, v57 row_shl:12 row_mask:0xf bank_mask:0xf bound_ctrl:0
    v_mfma_f32_16x16x32_bf16 v[60:63], v[120:123], v[104:107], v[60:63]
    s_nop 0
    v_mfma_f32_16x16x32_bf16 v[60:63], v[124:127], v[108:111], v[60:63]
    s_mov_b64 exec, 0xffff
    s_nop 6
    ds_write_b128 v13, v[60:63]
    s_mov_b64 exec, -1
    s_waitcnt lgkmcnt(0)
    s_barrier
    s_cmp_eq_u32 s4, 0
    s_cbranch_scc0 L_tend
    ds_read2st64_b32 v[40:41], v14 offset0:0 offset1:4
    ds_read2st64_b32 v[42:43], v14 offset0:8 offset1:12
    s_waitcnt lgkmcnt(0)
    v_pk_add_f32 v[40:41], v[40:41], v[42:43]
    v_add_f32 v40, v40, v41
    v_fma_f32 v40, v40, v21, v20
    v_cvt_pk_bf16_f32 v40, v40, v40
    buffer_store_short v40, v23, s[52:55], s42 offen
L_tend:
L_end:
    s_endpgm
.section .rodata,"a"
.p2align 6
.amdhsa_kernel adaLN_cond__gqa_block_cached__geglu_ffn__decode_kernel
  .amdhsa_next_free_vgpr 128
  .amdhsa_next_free_sgpr 100
  .amdhsa_accum_offset 128
  .amdhsa_float_denorm_mode_32 3
  .amdhsa_group_segment_fixed_size 0
  .amdhsa_kernarg_size 112
  .amdhsa_user_sgpr_count 2
  .amdhsa_user_sgpr_kernarg_segment_ptr 1
  .amdhsa_system_sgpr_workgroup_id_x 1
.end_amdhsa_kernel
```
